```python
import torch

def _softmax(x, axis=-1):
    return torch.softmax(x, dim=axis)

def _gelu(x):
    return torch.nn.functional.gelu(x, approximate='tanh')

def _silu(x):
    return torch.nn.functional.silu(x)

def _sigmoid(x):
    return torch.sigmoid(x)

def _layernorm(x, axis=-1, eps=1e-05):
    m = x.mean(dim=axis, keepdim=True)
    v = x.var(dim=axis, keepdim=True, unbiased=False)
    return (x - m) / torch.sqrt(v + eps)

def _scatter_add(tgt, idx, src, axis=0):
    return tgt.clone().index_add_(axis, idx, src)

def _segment_sum(src, seg, n):
    out = torch.zeros((n,) + src.shape[1:], dtype=src.dtype)
    return out.index_add_(0, seg, src)

def _pad(x, pw):
    flat = tuple((v for pair in reversed(pw) for v in pair))
    return torch.nn.functional.pad(x, flat)
kernel_name = 'standalone__tensor_product_equiv_equiformer__graph'

def setup_inputs():

    _w = lambda a: (lambda t: t.to(torch.bfloat16) if t.is_floating_point() else t)(torch.as_tensor(a))
    N, deg, C, De = (10000, 64, 64, max(4, 1))
    E = N * deg
    src = (lambda lo, hi, *s: torch.randint(lo, hi, s))(0, N, E).to(torch.int64)
    dst = (lambda lo, hi, *s: torch.randint(lo, hi, s))(0, N, E).to(torch.int64)
    rvec = (lambda *s: torch.randn(*s, dtype=torch.bfloat16) * 0.05)(E, 3).to(float)
    rn = (torch.linalg.norm(rvec, dim=-1, keepdim=True) + 1e-06).to(float)
    rhat = (rvec / rn).to(float)
    eps = torch.zeros((3, 3, 3), dtype=float)
    eps[0, 1, 2] = eps[1, 2, 0] = eps[2, 0, 1] = 1.0
    eps[0, 2, 1] = eps[2, 1, 0] = eps[1, 0, 2] = -1.0
    return {'x': _w((lambda *s: torch.randn(*s, dtype=torch.bfloat16) * 0.4)(N, 4 * C).to(float)), 'rhat': _w(rhat), 'e_attr': _w((lambda *s: torch.randn(*s, dtype=torch.bfloat16) * 0.4)(E, De).to(float)), 'src': _w(src), 'dst': _w(dst), 'w_rad': _w((lambda *s: torch.randn(*s, dtype=torch.bfloat16) * 0.4)(De, 5 * C).to(float)), 'w_si0': _w((lambda *s: torch.randn(*s, dtype=torch.bfloat16) * 0.4)(2 * C, C).to(float)), 'w_si1': _w((lambda *s: torch.randn(*s, dtype=torch.bfloat16) * 0.05)(3 * C, C).to(float)), 'cg_eps': _w(eps)}

def reference(x, rhat, e_attr, src, dst, w_rad, w_si0, w_si1, cg_eps):
    N = x.shape[0]
    C = w_si0.shape[1]
    E = rhat.shape[0]
    x0 = x[:, :C].clone()
    x1 = x[:, C:].reshape(N, 3, C)
    R = (e_attr @ w_rad).reshape(E, 5, C)
    f0 = x0[src]
    f1 = x1[src]
    Y1 = rhat
    p00_0 = f0 * R[:, 0, :]
    p11_0 = torch.einsum('ejc,ej->ec', f1, Y1) * R[:, 1, :]
    p01_1 = torch.einsum('ec,ej->ejc', f0, Y1) * R[:, 2, :][:, None, :]
    p10_1 = f1 * R[:, 3, :][:, None, :]
    p11_1 = torch.einsum('ijk,ekc,ej->eic', cg_eps, f1, Y1) * R[:, 4, :][:, None, :]
    m0 = torch.concatenate([p00_0, p11_0], axis=-1) @ w_si0
    m1 = torch.einsum('ejp,pc->ejc', torch.concatenate([p01_1, p10_1, p11_1], axis=-1), w_si1)
    agg0 = _segment_sum(m0, dst, N)
    agg1 = _segment_sum(m1.reshape(E, 3 * C), dst, N).reshape(N, 3, C)
    gate = _sigmoid(agg0)
    out1 = agg1 * gate[:, None, :]
    return torch.concatenate([agg0, out1.reshape(N, 3 * C)], axis=-1)
```

```asm
; @launch kernel=tp_part_kernel grid=(256,1,1) block=(704,1,1) lds=53760
; @launch kernel=tp_main_kernel grid=(256,1,1) block=(512,1,1) lds=162752
.amdgcn_target "amdgcn-amd-amdhsa--gfx950"
.text
.globl tp_part_kernel
.p2align 8
.type tp_part_kernel,@function
tp_part_kernel:
    s_cmp_ge_u32 s2, 256
    s_cbranch_scc1 K1_END
    s_load_dwordx4 s[4:7], s[0:1], 8
    s_load_dwordx4 s[8:11], s[0:1], 24
    s_load_dwordx2 s[16:17], s[0:1], 88
    s_load_dwordx2 s[64:65], s[0:1], 0
    v_lshrrev_b32 v70, 6, v0
    v_lshlrev_b32 v1, 2, v0
    v_readfirstlane_b32 s50, v70
    s_mul_i32 s3, s2, 2500
    v_add_u32 v2, s3, v1
    v_lshlrev_b32 v3, 2, v2
    v_lshlrev_b32 v40, 3, v2
    v_mul_u32_u24 v41, 6, v2
    s_cmp_eq_u32 s50, 10
    s_cbranch_scc1 K1_AUX
    s_waitcnt lgkmcnt(0)
    s_mov_b32 s20, s10
    s_and_b32 s21, s11, 0xffff
    s_mov_b32 s22, 2560000
    s_mov_b32 s23, 0x00020000
    buffer_load_dwordx4 v[4:7], v3, s[20:23], 0 offen nt
    s_mov_b32 s24, s8
    s_and_b32 s25, s9, 0xffff
    s_mov_b32 s26, 2560000
    s_mov_b32 s27, 0x00020000
    s_mov_b32 s28, s6
    s_and_b32 s29, s7, 0xffff
    s_mov_b32 s30, 5120000
    s_mov_b32 s31, 0x00020000
    s_mov_b32 s32, s4
    s_and_b32 s33, s5, 0xffff
    s_mov_b32 s34, 3840000
    s_mov_b32 s35, 0x00020000
    v_lshlrev_b32 v71, 4, v0
    v_and_b32 v70, 63, v0
    v_lshlrev_b32 v70, 4, v70
    s_cmp_lt_u32 s50, 8
    s_cselect_b32 s51, -1, 0
    v_mov_b32 v60, s51
    v_mov_b32 v61, s51
    v_mov_b32 v62, s51
    v_mov_b32 v63, s51
    s_cbranch_scc0 K1_INIT2
    ds_write_b128 v71, v[60:63] offset:4608
    s_branch K1_INIT3
K1_INIT2:
    ds_write_b128 v70, v[60:63] offset:0
K1_INIT3:
    s_mul_i32 s36, s2, 40000
    s_add_u32 s36, s16, s36
    s_addc_u32 s37, s17, 0
    s_and_b32 s37, s37, 0xffff
    s_mov_b32 s38, 40000
    s_mov_b32 s39, 0x00020000
    s_add_u32 s40, s3, 10240000
    s_add_u32 s40, s16, s40
    s_addc_u32 s41, s17, 0
    s_and_b32 s41, s41, 0xffff
    s_mov_b32 s42, 2500
    s_mov_b32 s43, 0x00020000
    s_mov_b32 s44, s16
    s_and_b32 s45, s17, 0xffff
    s_mov_b32 s46, 42121216
    s_mov_b32 s47, 0x00020000
    s_mov_b32 s62, 0x05040100
    s_mov_b32 s63, 0x05040302
    v_add_u32 v72, 10240, v71
    v_add_u32 v73, 20480, v71
    v_add_u32 v74, 30720, v71
    s_waitcnt lgkmcnt(0)
    s_barrier
    buffer_load_dwordx4 v[8:11], v3, s[24:27], 0 offen nt
    buffer_load_dwordx3 v[20:22], v41, s[32:35], 0 offen
    buffer_load_dwordx3 v[24:26], v41, s[32:35], 0 offen offset:12
    v_cmp_gt_u32 vcc, 625, v0
    s_mov_b64 s[60:61], vcc
    s_mov_b64 exec, vcc
    v_mov_b32 v2, 1
    s_waitcnt vmcnt(3)
    v_mul_u32_u24 v4, 1677, v4
    v_mul_u32_u24 v5, 1677, v5
    v_mul_u32_u24 v6, 1677, v6
    v_mul_u32_u24 v7, 1677, v7
    v_lshrrev_b32 v28, 14, v4
    v_lshrrev_b32 v29, 14, v5
    v_lshrrev_b32 v30, 14, v6
    v_lshrrev_b32 v31, 14, v7
    v_and_b32 v28, 0x3fc, v28
    v_and_b32 v29, 0x3fc, v29
    v_and_b32 v30, 0x3fc, v30
    v_and_b32 v31, 0x3fc, v31
    ds_add_rtn_u32 v32, v28, v2 offset:0
    ds_add_rtn_u32 v33, v29, v2 offset:0
    ds_add_rtn_u32 v34, v30, v2 offset:0
    ds_add_rtn_u32 v35, v31, v2 offset:0
    s_mov_b64 exec, -1
    s_waitcnt lgkmcnt(0)
    s_barrier
    ds_read_b128 v[56:59], v70 offset:0
    buffer_load_dwordx4 v[12:15], v40, s[28:31], 0 offen
    buffer_load_dwordx4 v[16:19], v40, s[28:31], 0 offen offset:16
    v_and_b32 v4, 0xffff, v4
    v_mul_u32_u24 v4, 40018, v4
    v_bfe_u32 v36, v4, 26, 3
    v_lshrrev_b32 v4, 29, v4
    v_lshl_add_u32 v4, v36, 4, v4
    v_and_b32 v5, 0xffff, v5
    v_mul_u32_u24 v5, 40018, v5
    v_bfe_u32 v37, v5, 26, 3
    v_lshrrev_b32 v5, 29, v5
    v_lshl_add_u32 v5, v37, 4, v5
    v_and_b32 v6, 0xffff, v6
    v_mul_u32_u24 v6, 40018, v6
    v_bfe_u32 v38, v6, 26, 3
    v_lshrrev_b32 v6, 29, v6
    v_lshl_add_u32 v6, v38, 4, v6
    v_and_b32 v7, 0xffff, v7
    v_mul_u32_u24 v7, 40018, v7
    v_bfe_u32 v39, v7, 26, 3
    v_lshrrev_b32 v7, 29, v7
    v_lshl_add_u32 v7, v39, 4, v7
    s_waitcnt lgkmcnt(0)
    v_add_u32 v64, v56, v57
    v_add_u32 v65, v64, v58
    v_add_u32 v66, v65, v59
    v_mov_b32 v67, v66
    v_max3_u32 v68, v56, v57, v58
    v_max_u32 v68, v68, v59
    v_cmp_lt_u32 vcc, 30, v68
    s_mov_b64 s[54:55], vcc
    v_min_u32 v48, 29, v32
    v_lshlrev_b32 v48, 1, v48
    v_add_u32_dpp v67, v67, v67 row_shr:1 row_mask:0xf bank_mask:0xf bound_ctrl:0
    v_subrev_u32 v52, 29, v48
    v_min_u32 v48, v48, v52
    v_add_u32_dpp v67, v67, v67 row_shr:2 row_mask:0xf bank_mask:0xf bound_ctrl:0
    v_min_u32 v49, 29, v33
    v_lshlrev_b32 v49, 1, v49
    v_add_u32_dpp v67, v67, v67 row_shr:4 row_mask:0xf bank_mask:0xf bound_ctrl:0
    v_subrev_u32 v53, 29, v49
    v_min_u32 v49, v49, v53
    v_add_u32_dpp v67, v67, v67 row_shr:8 row_mask:0xf bank_mask:0xf bound_ctrl:0
    v_min_u32 v50, 29, v34
    v_lshlrev_b32 v50, 1, v50
    v_add_u32_dpp v67, v67, v67 row_bcast:15 row_mask:0xa bank_mask:0xf
    v_subrev_u32 v54, 29, v50
    v_min_u32 v50, v50, v54
    v_add_u32_dpp v67, v67, v67 row_bcast:31 row_mask:0xc bank_mask:0xf
    v_sub_u32 v60, v67, v66
    v_add_u32 v61, v60, v56
    v_add_u32 v62, v60, v64
    v_add_u32 v63, v60, v65
    ds_write_b128 v70, v[60:63] offset:1024
    ds_read_b32 v36, v28 offset:1024
    ds_read_b32 v37, v29 offset:1024
    ds_read_b32 v38, v30 offset:1024
    ds_read_b32 v39, v31 offset:1024
    v_min_u32 v51, 29, v35
    v_lshlrev_b32 v51, 1, v51
    v_subrev_u32 v55, 29, v51
    v_min_u32 v51, v51, v55
    v_lshl_add_u32 v48, v28, 3, v48
    v_lshl_add_u32 v49, v29, 3, v49
    v_lshl_add_u32 v50, v30, 3, v50
    v_lshl_add_u32 v51, v31, 3, v51
    s_cmp_lt_u32 s50, 8
    s_cbranch_scc1 K1_NOTAB
    v_lshlrev_b32 v68, 3, v70
    v_cmp_lt_u32 vcc, 30, v56
    v_or_b32 v69, 0x8000, v60
    v_lshl_or_b32 v56, v56, 16, v60
    v_cndmask_b32 v69, v60, v69, vcc
    ds_write_b16 v68, v69 offset:4638
    v_cmp_lt_u32 vcc, 30, v57
    v_or_b32 v69, 0x8000, v61
    v_lshl_or_b32 v57, v57, 16, v61
    v_cndmask_b32 v69, v61, v69, vcc
    ds_write_b16 v68, v69 offset:4670
    v_cmp_lt_u32 vcc, 30, v58
    v_or_b32 v69, 0x8000, v62
    v_lshl_or_b32 v58, v58, 16, v62
    v_cndmask_b32 v69, v62, v69, vcc
    ds_write_b16 v68, v69 offset:4702
    v_cmp_lt_u32 vcc, 30, v59
    v_or_b32 v69, 0x8000, v63
    v_lshl_or_b32 v59, v59, 16, v63
    v_cndmask_b32 v69, v63, v69, vcc
    ds_write_b16 v68, v69 offset:4734
K1_NOTAB:
    s_mov_b64 exec, s[60:61]
    ds_write_b8 v48, v4 offset:4608
    ds_write_b8 v49, v5 offset:4608
    ds_write_b8 v50, v6 offset:4608
    ds_write_b8 v51, v7 offset:4608
    s_waitcnt lgkmcnt(4)
    v_add_u32 v36, v36, v32
    v_add_u32 v37, v37, v33
    v_add_u32 v38, v38, v34
    v_add_u32 v39, v39, v35
    s_cmp_eq_u64 s[54:55], 0
    s_cbranch_scc1 K1_NOKEY
    ds_write_b8 v36, v4 offset:2048
    ds_write_b8 v37, v5 offset:2048
    ds_write_b8 v38, v6 offset:2048
    ds_write_b8 v39, v7 offset:2048
    s_waitcnt lgkmcnt(0)
K1_NOKEY:
    v_lshlrev_b32 v32, 4, v36
    v_add_u32 v32, 12800, v32
    v_lshlrev_b32 v33, 4, v37
    v_add_u32 v33, 12800, v33
    v_lshlrev_b32 v34, 4, v38
    v_add_u32 v34, 12800, v34
    v_lshlrev_b32 v35, 4, v39
    v_add_u32 v35, 12800, v35
    s_waitcnt vmcnt(2)
    v_alignbit_b32 v44, v22, v21, 16
    v_perm_b32 v45, v9, v22, s63
    v_perm_b32 v21, v8, v21, s62
    v_alignbit_b32 v46, v26, v25, 16
    v_perm_b32 v47, v11, v26, s63
    v_perm_b32 v25, v10, v25, s62
    ds_write_b64 v32, v[20:21] offset:8
    ds_write_b64 v33, v[44:45] offset:8
    ds_write_b64 v34, v[24:25] offset:8
    ds_write_b64 v35, v[46:47] offset:8
    s_waitcnt vmcnt(1)
    ds_write_b64 v32, v[12:13]
    ds_write_b64 v33, v[14:15]
    s_waitcnt vmcnt(0)
    ds_write_b64 v34, v[16:17]
    ds_write_b64 v35, v[18:19]
    s_mov_b64 exec, -1
    s_waitcnt lgkmcnt(0)
    s_barrier
    ds_read_b128 v[4:7], v71 offset:12800
    ds_read_b128 v[8:11], v71 offset:23040
    ds_read_b128 v[12:15], v71 offset:33280
    ds_read_b128 v[16:19], v71 offset:43520
    ds_read_b128 v[60:63], v71 offset:4608
    ds_read_b32 v20, v1 offset:2048
    s_waitcnt lgkmcnt(5)
    buffer_store_dwordx4 v[4:7], v71, s[36:39], 0 offen sc1
    s_waitcnt lgkmcnt(4)
    buffer_store_dwordx4 v[8:11], v72, s[36:39], 0 offen sc1
    s_waitcnt lgkmcnt(3)
    buffer_store_dwordx4 v[12:15], v73, s[36:39], 0 offen sc1
    s_waitcnt lgkmcnt(2)
    buffer_store_dwordx4 v[16:19], v74, s[36:39], 0 offen sc1
    s_cmp_lt_u32 s50, 8
    s_cbranch_scc0 K1_NT2
    s_lshl_b32 s52, s2, 13
    s_add_u32 s52, s52, 11142144
    s_waitcnt lgkmcnt(1)
    buffer_store_dwordx4 v[60:63], v71, s[44:47], s52 offen sc1
    s_branch K1_NT1
K1_NT2:
    s_lshl_b32 s52, s2, 10
    s_add_u32 s52, s52, 10880000
    buffer_store_dwordx4 v[56:59], v70, s[44:47], s52 offen sc1
K1_NT1:
    s_cmp_eq_u64 s[54:55], 0
    s_cbranch_scc1 K1_NOKEY2
    s_waitcnt lgkmcnt(0)
    buffer_store_dword v20, v1, s[40:43], 0 offen
K1_NOKEY2:
K1_END:
    s_endpgm
K1_AUX:
    s_load_dwordx2 s[18:19], s[0:1], 40
    s_load_dwordx4 s[12:15], s[0:1], 48
    v_and_b32 v0, 63, v0
    s_barrier
    s_waitcnt lgkmcnt(0)
    s_getpc_b64 s[66:67]
K1_PC:
    s_lshr_b32 s68, s2, 3
    s_lshl_b32 s68, s68, 9
    s_min_u32 s68, s68, CODE_END-K1_PC-452
    s_load_dword s32, s[66:67], s68
    s_add_u32 s68, s68, 64
    s_load_dword s33, s[66:67], s68
    s_add_u32 s68, s68, 64
    s_load_dword s34, s[66:67], s68
    s_add_u32 s68, s68, 64
    s_load_dword s35, s[66:67], s68
    s_add_u32 s68, s68, 64
    s_load_dword s36, s[66:67], s68
    s_add_u32 s68, s68, 64
    s_load_dword s37, s[66:67], s68
    s_add_u32 s68, s68, 64
    s_load_dword s38, s[66:67], s68
    s_add_u32 s68, s68, 64
    s_load_dword s39, s[66:67], s68
    s_add_u32 s68, s68, 64
    s_barrier
    s_cmp_ge_u32 s2, 45
    s_cbranch_scc1 K1_END
    s_mov_b32 s44, s16
    s_and_b32 s45, s17, 0xffff
    s_mov_b32 s46, 42121216
    s_mov_b32 s47, 0x00020000
    s_cmp_ge_u32 s2, 40
    s_cbranch_scc1 K1_AUXR
    s_mul_i32 s51, s2, 26
    s_lshr_b32 s51, s51, 8
    s_mul_i32 s52, s51, 10
    s_sub_u32 s52, s2, s52
    s_cmp_lt_u32 s52, 4
    s_cselect_b32 s56, s12, s14
    s_cselect_b32 s57, s13, s15
    s_movk_i32 s58, 16384
    s_cselect_b32 s58, s58, 24576
    s_and_b32 s57, s57, 0xffff
    s_mov_b32 s59, 0x00020000
    v_lshrrev_b32 v70, 4, v0
    v_and_b32 v71, 15, v0
    v_lshlrev_b32 v71, 1, v71
    s_lshl_b32 s53, s51, 5
    v_add_u32 v71, s53, v71
    s_cmp_ge_u32 s52, 8
    s_cbranch_scc1 K1_FRAGX
    s_and_b32 s53, s52, 1
    s_lshl_b32 s53, s53, 5
    s_bfe_u32 s55, s52, 0x10001
    s_add_u32 s53, s53, s55
    s_lshl_b32 s53, s53, 7
    v_lshl_add_u32 v71, v70, 10, v71
    v_add_u32 v71, s53, v71
    v_add_u32 v72, 8192, v71
    buffer_load_ushort v48, v71, s[56:59], 0 offen offset:0
    buffer_load_ushort v49, v72, s[56:59], 0 offen offset:0
    buffer_load_ushort v50, v71, s[56:59], 0 offen offset:256
    buffer_load_ushort v51, v72, s[56:59], 0 offen offset:256
    buffer_load_ushort v52, v71, s[56:59], 0 offen offset:512
    buffer_load_ushort v53, v72, s[56:59], 0 offen offset:512
    buffer_load_ushort v54, v71, s[56:59], 0 offen offset:768
    buffer_load_ushort v55, v72, s[56:59], 0 offen offset:768
    s_branch K1_FRAGW
K1_FRAGX:
    s_and_b32 s53, s52, 1
    s_add_u32 s53, s53, 128
    s_lshl_b32 s53, s53, 7
    v_lshl_add_u32 v71, v70, 11, v71
    v_add_u32 v71, s53, v71
    buffer_load_ushort v48, v71, s[56:59], 0 offen offset:0
    buffer_load_ushort v49, v71, s[56:59], 0 offen offset:256
    buffer_load_ushort v50, v71, s[56:59], 0 offen offset:512
    buffer_load_ushort v51, v71, s[56:59], 0 offen offset:768
    buffer_load_ushort v52, v71, s[56:59], 0 offen offset:1024
    buffer_load_ushort v53, v71, s[56:59], 0 offen offset:1280
    buffer_load_ushort v54, v71, s[56:59], 0 offen offset:1536
    buffer_load_ushort v55, v71, s[56:59], 0 offen offset:1792
K1_FRAGW:
    s_barrier
    s_waitcnt vmcnt(0)
    v_lshl_or_b32 v48, v49, 16, v48
    v_lshl_or_b32 v49, v51, 16, v50
    v_lshl_or_b32 v50, v53, 16, v52
    v_lshl_or_b32 v51, v55, 16, v54
    s_branch K1_AUXS
K1_AUXR:
    s_mov_b32 s56, s18
    s_and_b32 s57, s19, 0xffff
    s_mov_b32 s58, 2560
    s_mov_b32 s59, 0x00020000
    v_and_b32 v70, 31, v0
    v_lshrrev_b32 v71, 5, v0
    v_lshlrev_b32 v70, 2, v70
    v_lshl_add_u32 v70, v71, 1, v70
    s_sub_u32 s52, s2, 40
    s_lshl_b32 s52, s52, 7
    v_add_u32 v70, s52, v70
    buffer_load_ushort v48, v70, s[56:59], 0 offen offset:0
    buffer_load_ushort v49, v70, s[56:59], 0 offen offset:640
    buffer_load_ushort v50, v70, s[56:59], 0 offen offset:1280
    buffer_load_ushort v51, v70, s[56:59], 0 offen offset:1920
    s_barrier
    s_waitcnt vmcnt(0)
    v_lshlrev_b32 v48, 16, v48
    v_lshlrev_b32 v49, 16, v49
    v_lshlrev_b32 v50, 16, v50
    v_lshlrev_b32 v51, 16, v51
K1_AUXS:
    s_lshl_b32 s52, s2, 10
    s_add_u32 s52, s52, 13239296
    v_lshlrev_b32 v70, 4, v0
    buffer_store_dwordx4 v[48:51], v70, s[44:47], s52 offen sc1
    s_endpgm
.globl tp_main_kernel
.p2align 8
.type tp_main_kernel,@function
tp_main_kernel:
    s_cmp_ge_u32 s2, 256
    s_cbranch_scc1 K2_END
    s_load_dwordx2 s[4:5], s[0:1], 0
    s_load_dwordx2 s[8:9], s[0:1], 72
    s_load_dwordx2 s[10:11], s[0:1], 88
    v_lshrrev_b32 v1, 6, v0
    v_and_b32 v125, 63, v0
    v_readfirstlane_b32 s30, v1
    s_and_b32 s28, s2, 7
    s_lshl_b32 s28, s28, 5
    s_lshr_b32 s47, s2, 3
    s_add_u32 s28, s28, s47
    v_lshrrev_b32 v126, 4, v125
    s_lshl_b32 s47, s30, 5
    v_add_u32 v126, s47, v126
    v_and_b32 v127, 15, v125
    v_lshlrev_b32 v120, 10, v126
    v_lshlrev_b32 v121, 13, v126
    v_lshl_add_u32 v121, v127, 1, v121
    s_lshl_b32 s47, s28, 5
    s_add_u32 s47, s47, 11142144
    s_waitcnt lgkmcnt(0)
    s_mov_b32 s16, s10
    s_and_b32 s17, s11, 0xffff
    s_mov_b32 s18, 42121216
    s_mov_b32 s19, 0x00020000
    buffer_load_ushort v72, v121, s[16:19], s47 offen
    s_add_u32 s47, s47, 32768
    buffer_load_ushort v73, v121, s[16:19], s47 offen
    s_add_u32 s47, s47, 32768
    buffer_load_ushort v74, v121, s[16:19], s47 offen
    s_add_u32 s47, s47, 32768
    buffer_load_ushort v75, v121, s[16:19], s47 offen
    s_add_u32 s47, s47, 32768
    buffer_load_ushort v76, v121, s[16:19], s47 offen
    s_add_u32 s47, s47, 32768
    buffer_load_ushort v77, v121, s[16:19], s47 offen
    s_add_u32 s47, s47, 32768
    buffer_load_ushort v78, v121, s[16:19], s47 offen
    s_add_u32 s47, s47, 32768
    buffer_load_ushort v79, v121, s[16:19], s47 offen
    v_lshlrev_b32 v188, 4, v0
    v_min_u32 v188, 5104, v188
    s_mov_b32 s47, 13280256
    buffer_load_dwordx4 v[184:187], v188, s[16:19], s47 offen
    s_mov_b32 s12, s4
    s_and_b32 s13, s5, 0xffff
    s_mov_b32 s14, 5120000
    s_mov_b32 s15, 0x00020000
    v_and_b32 v122, 31, v125
    v_lshlrev_b32 v251, 2, v122
    v_lshrrev_b32 v123, 5, v125
    s_lshl_b32 s47, s28, 16
    s_add_u32 s47, s47, 1676
    s_mul_hi_u32 s48, s47, 0x27144e
    s_add_u32 s47, s47, 0x10000
    s_mul_hi_u32 s47, s47, 0x27144e
    s_min_u32 s47, s47, 10000
    s_sub_u32 s29, s47, s48
    s_lshl_b32 s47, s48, 9
    s_add_u32 s20, s8, s47
    s_addc_u32 s21, s9, 0
    s_and_b32 s21, s21, 0xffff
    s_lshl_b32 s22, s29, 9
    s_mov_b32 s23, 0x00020000
    s_mov_b32 s31, 0
    s_mov_b32 s38, 0
    s_lshr_b32 s88, s30, 2
    s_mov_b32 s32, 0
    v_lshrrev_b32 v5, 3, v0
    v_and_b32 v6, 7, v0
    v_lshlrev_b32 v6, 1, v6
    v_sub_u32 v5, v5, v6
    v_med3_i32 v5, v5, 0, 2
    v_lshlrev_b32 v5, 4, v5
    v_mov_b32 v6, -1
    v_mov_b32 v7, 0
    v_lshlrev_b64 v[6:7], v5, v[6:7]
    v_cmp_gt_u32 vcc, 256, v0
    v_lshlrev_b32 v3, 2, v0
    v_add_u32 v3, 76800, v3
    v_cndmask_b32 v2, 0, v7, vcc
    ds_write_b32 v3, v2
    v_mov_b32 v2, 0
    v_mov_b32 v3, 78848
    ds_write2_b32 v3, v2, v2 offset0:0 offset1:1
    ds_write_b32 v3, v2 offset:8
    v_mov_b32 v244, 0
    v_mov_b32 v245, 0
    v_and_b32 v4, 1, v125
    v_sub_u32 v254, 0, v4
    v_bfe_u32 v4, v125, 2, 1
    v_mul_u32_u24 v255, 0x5555, v4
    v_add_u32 v255, 0x8888, v255
    v_lshlrev_b32 v252, 4, v123
    v_add_u32 v252, 76800, v252
    s_waitcnt lgkmcnt(0)
    s_movk_i32 s47, 2500
    v_mad_u32_u24 v122, v126, s47, v127
    s_mov_b32 s24, 0x7fff7fff
    s_mov_b32 s25, 0x7fff7fff
    s_mov_b64 s[26:27], -1
    s_mov_b64 s[52:53], 0
    v_mov_b32 v124, 77824
    v_lshlrev_b32 v121, 4, v125
    s_barrier
    v_mov_b32 v120, 1
    s_waitcnt vmcnt(8)
    v_mov_b32_dpp v112, v72 row_newbcast:15 row_mask:0xf bank_mask:0xf
    v_and_b32 v96, 0xff, v72
    v_and_b32 v112, 0xfff, v112
    v_cmp_gt_u32 vcc, 0x80, v96
    v_add_lshl_u32 v112, v112, v122, 4
    v_lshl_add_u32 v96, v96, 2, v124
    s_and_b64 s[56:57], vcc, s[24:25]
    s_mov_b32 s47, 0
    s_or_b64 exec, s[56:57], 1
    buffer_load_dwordx4 v[0:3], v112, s[16:19], s47 offen
    s_mov_b64 exec, -1
    v_cmp_gt_u32 vcc, 0x8000, v72
    s_mov_b64 exec, s[56:57]
    ds_add_rtn_u32 v80, v96, v120
    s_mov_b64 exec, -1
    s_and_b64 s[72:73], vcc, s[24:25]
    s_and_b64 s[26:27], s[26:27], vcc
    s_or_b64 s[52:53], s[52:53], s[72:73]
    s_waitcnt vmcnt(8)
    v_mov_b32_dpp v113, v73 row_newbcast:15 row_mask:0xf bank_mask:0xf
    v_and_b32 v97, 0xff, v73
    v_and_b32 v113, 0xfff, v113
    v_cmp_gt_u32 vcc, 0x80, v97
    v_add_lshl_u32 v113, v113, v122, 4
    v_lshl_add_u32 v97, v97, 2, v124
    s_and_b64 s[58:59], vcc, s[24:25]
    s_mov_b32 s47, 160000
    s_or_b64 exec, s[58:59], 1
    buffer_load_dwordx4 v[4:7], v113, s[16:19], s47 offen
    s_mov_b64 exec, -1
    v_cmp_gt_u32 vcc, 0x8000, v73
    s_mov_b64 exec, s[58:59]
    ds_add_rtn_u32 v81, v97, v120
    s_mov_b64 exec, -1
    s_and_b64 s[74:75], vcc, s[24:25]
    s_and_b64 s[26:27], s[26:27], vcc
    s_or_b64 s[52:53], s[52:53], s[74:75]
    s_waitcnt vmcnt(8)
    v_mov_b32_dpp v114, v74 row_newbcast:15 row_mask:0xf bank_mask:0xf
    v_and_b32 v98, 0xff, v74
    v_and_b32 v114, 0xfff, v114
    v_cmp_gt_u32 vcc, 0x80, v98
    v_add_lshl_u32 v114, v114, v122, 4
    v_lshl_add_u32 v98, v98, 2, v124
    s_and_b64 s[60:61], vcc, s[24:25]
    s_mov_b32 s47, 320000
    s_or_b64 exec, s[60:61], 1
    buffer_load_dwordx4 v[8:11], v114, s[16:19], s47 offen
    s_mov_b64 exec, -1
    v_cmp_gt_u32 vcc, 0x8000, v74
    s_mov_b64 exec, s[60:61]
    ds_add_rtn_u32 v82, v98, v120
    s_mov_b64 exec, -1
    s_and_b64 s[76:77], vcc, s[24:25]
    s_and_b64 s[26:27], s[26:27], vcc
    s_or_b64 s[52:53], s[52:53], s[76:77]
    s_waitcnt vmcnt(8)
    v_mov_b32_dpp v115, v75 row_newbcast:15 row_mask:0xf bank_mask:0xf
    v_and_b32 v99, 0xff, v75
    v_and_b32 v115, 0xfff, v115
    v_cmp_gt_u32 vcc, 0x80, v99
    v_add_lshl_u32 v115, v115, v122, 4
    v_lshl_add_u32 v99, v99, 2, v124
    s_and_b64 s[62:63], vcc, s[24:25]
    s_mov_b32 s47, 480000
    s_or_b64 exec, s[62:63], 1
    buffer_load_dwordx4 v[12:15], v115, s[16:19], s47 offen
    s_mov_b64 exec, -1
    v_cmp_gt_u32 vcc, 0x8000, v75
    s_mov_b64 exec, s[62:63]
    ds_add_rtn_u32 v83, v99, v120
    s_mov_b64 exec, -1
    s_and_b64 s[78:79], vcc, s[24:25]
    s_and_b64 s[26:27], s[26:27], vcc
    s_or_b64 s[52:53], s[52:53], s[78:79]
    s_waitcnt vmcnt(8)
    v_mov_b32_dpp v116, v76 row_newbcast:15 row_mask:0xf bank_mask:0xf
    v_and_b32 v100, 0xff, v76
    v_and_b32 v116, 0xfff, v116
    v_cmp_gt_u32 vcc, 0x80, v100
    v_add_lshl_u32 v116, v116, v122, 4
    v_lshl_add_u32 v100, v100, 2, v124
    s_and_b64 s[64:65], vcc, s[24:25]
    v_cmp_gt_u32 vcc, 0x8000, v76
    s_mov_b64 exec, s[64:65]
    ds_add_rtn_u32 v84, v100, v120
    s_mov_b64 exec, -1
    s_and_b64 s[80:81], vcc, s[24:25]
    s_and_b64 s[26:27], s[26:27], vcc
    s_or_b64 s[52:53], s[52:53], s[80:81]
    s_waitcnt vmcnt(7)
    v_mov_b32_dpp v117, v77 row_newbcast:15 row_mask:0xf bank_mask:0xf
    v_and_b32 v101, 0xff, v77
    v_and_b32 v117, 0xfff, v117
    v_cmp_gt_u32 vcc, 0x80, v101
    v_add_lshl_u32 v117, v117, v122, 4
    v_lshl_add_u32 v101, v101, 2, v124
    s_and_b64 s[66:67], vcc, s[24:25]
    v_cmp_gt_u32 vcc, 0x8000, v77
    s_mov_b64 exec, s[66:67]
    ds_add_rtn_u32 v85, v101, v120
    s_mov_b64 exec, -1
    s_and_b64 s[82:83], vcc, s[24:25]
    s_and_b64 s[26:27], s[26:27], vcc
    s_or_b64 s[52:53], s[52:53], s[82:83]
    s_waitcnt vmcnt(6)
    v_mov_b32_dpp v118, v78 row_newbcast:15 row_mask:0xf bank_mask:0xf
    v_and_b32 v102, 0xff, v78
    v_and_b32 v118, 0xfff, v118
    v_cmp_gt_u32 vcc, 0x80, v102
    v_add_lshl_u32 v118, v118, v122, 4
    v_lshl_add_u32 v102, v102, 2, v124
    s_and_b64 s[68:69], vcc, s[24:25]
    v_cmp_gt_u32 vcc, 0x8000, v78
    s_mov_b64 exec, s[68:69]
    ds_add_rtn_u32 v86, v102, v120
    s_mov_b64 exec, -1
    s_and_b64 s[84:85], vcc, s[24:25]
    s_and_b64 s[26:27], s[26:27], vcc
    s_or_b64 s[52:53], s[52:53], s[84:85]
    s_waitcnt vmcnt(5)
    v_mov_b32_dpp v119, v79 row_newbcast:15 row_mask:0xf bank_mask:0xf
    v_and_b32 v103, 0xff, v79
    v_and_b32 v119, 0xfff, v119
    v_cmp_gt_u32 vcc, 0x80, v103
    v_add_lshl_u32 v119, v119, v122, 4
    v_lshl_add_u32 v103, v103, 2, v124
    s_and_b64 s[70:71], vcc, s[24:25]
    v_cmp_gt_u32 vcc, 0x8000, v79
    s_mov_b64 exec, s[70:71]
    ds_add_rtn_u32 v87, v103, v120
    s_mov_b64 exec, -1
    s_and_b64 s[86:87], vcc, s[24:25]
    s_and_b64 s[26:27], s[26:27], vcc
    s_or_b64 s[52:53], s[52:53], s[86:87]
    s_cbranch_scc0 K2_NO2B
    s_waitcnt lgkmcnt(4)
    s_mov_b64 exec, s[72:73]
    s_cbranch_execz K2_NK20
    v_lshrrev_b32 v104, 8, v72
    v_lshl_add_u32 v104, v104, 2, v124
    ds_add_rtn_u32 v88, v104, v120
K2_NK20:
    s_mov_b64 exec, s[74:75]
    s_cbranch_execz K2_NK21
    v_lshrrev_b32 v105, 8, v73
    v_lshl_add_u32 v105, v105, 2, v124
    ds_add_rtn_u32 v89, v105, v120
K2_NK21:
    s_mov_b64 exec, s[76:77]
    s_cbranch_execz K2_NK22
    v_lshrrev_b32 v106, 8, v74
    v_lshl_add_u32 v106, v106, 2, v124
    ds_add_rtn_u32 v90, v106, v120
K2_NK22:
    s_mov_b64 exec, s[78:79]
    s_cbranch_execz K2_NK23
    v_lshrrev_b32 v107, 8, v75
    v_lshl_add_u32 v107, v107, 2, v124
    ds_add_rtn_u32 v91, v107, v120
K2_NK23:
    s_mov_b64 exec, s[80:81]
    s_cbranch_execz K2_NK24
    v_lshrrev_b32 v108, 8, v76
    v_lshl_add_u32 v108, v108, 2, v124
    ds_add_rtn_u32 v92, v108, v120
K2_NK24:
    s_mov_b64 exec, s[82:83]
    s_cbranch_execz K2_NK25
    v_lshrrev_b32 v109, 8, v77
    v_lshl_add_u32 v109, v109, 2, v124
    ds_add_rtn_u32 v93, v109, v120
K2_NK25:
    s_mov_b64 exec, s[84:85]
    s_cbranch_execz K2_NK26
    v_lshrrev_b32 v110, 8, v78
    v_lshl_add_u32 v110, v110, 2, v124
    ds_add_rtn_u32 v94, v110, v120
K2_NK26:
    s_mov_b64 exec, s[86:87]
    s_cbranch_execz K2_NK27
    v_lshrrev_b32 v111, 8, v79
    v_lshl_add_u32 v111, v111, 2, v124
    ds_add_rtn_u32 v95, v111, v120
K2_NK27:
    s_mov_b64 exec, -1
K2_NO2B:
    v_add_u32 v188, 136512, v188
    s_or_b64 s[26:27], s[26:27], s[24:25]
    s_cmp_eq_u64 s[26:27], -1
    s_cbranch_scc1 K2_RANKD
    v_mov_b32 v120, 78848
    ds_write_b32 v120, v120
K2_RANKD:
    v_lshlrev_b32 v218, 2, v125
    v_add_u32 v218, 77824, v218
    v_mov_b32 v219, 78848
    s_waitcnt lgkmcnt(0)
    s_barrier
    ds_read2st64_b32 v[204:205], v218 offset0:0 offset1:1
    ds_read_b32 v219, v219
    s_cmp_lg_u32 s31, 0
    s_cbranch_scc1 K2_NOLATE
    s_mov_b32 s47, 640000
    s_or_b64 exec, s[64:65], 1
    buffer_load_dwordx4 v[16:19], v116, s[16:19], s47 offen
    s_mov_b64 exec, -1
    s_mov_b32 s47, 800000
    s_or_b64 exec, s[66:67], 1
    buffer_load_dwordx4 v[20:23], v117, s[16:19], s47 offen
    s_mov_b64 exec, -1
K2_NOLATE:
    s_waitcnt lgkmcnt(0)
    v_mov_b32 v206, v204
    v_mov_b32 v207, v205
    v_readfirstlane_b32 s49, v219
    v_add_u32_dpp v206, v206, v206 row_shr:1 row_mask:0xf bank_mask:0xf bound_ctrl:0
    v_add_u32_dpp v207, v207, v207 row_shr:1 row_mask:0xf bank_mask:0xf bound_ctrl:0
    s_nop 0
    v_add_u32_dpp v206, v206, v206 row_shr:2 row_mask:0xf bank_mask:0xf bound_ctrl:0
    v_add_u32_dpp v207, v207, v207 row_shr:2 row_mask:0xf bank_mask:0xf bound_ctrl:0
    s_nop 0
    v_add_u32_dpp v206, v206, v206 row_shr:4 row_mask:0xf bank_mask:0xf bound_ctrl:0
    v_add_u32_dpp v207, v207, v207 row_shr:4 row_mask:0xf bank_mask:0xf bound_ctrl:0
    s_nop 0
    v_add_u32_dpp v206, v206, v206 row_shr:8 row_mask:0xf bank_mask:0xf bound_ctrl:0
    v_add_u32_dpp v207, v207, v207 row_shr:8 row_mask:0xf bank_mask:0xf bound_ctrl:0
    s_nop 0
    v_mov_b32_dpp v208, v206 row_newbcast:15 row_mask:0xf bank_mask:0xf
    v_mov_b32_dpp v209, v207 row_newbcast:15 row_mask:0xf bank_mask:0xf
    v_add_u32 v210, 15, v208
    v_add_u32 v211, 15, v209
    v_and_b32 v210, -16, v210
    v_and_b32 v211, -16, v211
    v_mov_b32 v212, v210
    v_mov_b32 v213, v211
    v_add_u32_dpp v210, v210, v210 row_bcast:15 row_mask:0xa bank_mask:0xf
    v_add_u32_dpp v211, v211, v211 row_bcast:15 row_mask:0xa bank_mask:0xf
    s_nop 0
    v_add_u32_dpp v210, v210, v210 row_bcast:31 row_mask:0xc bank_mask:0xf
    v_add_u32_dpp v211, v211, v211 row_bcast:31 row_mask:0xc bank_mask:0xf
    s_nop 0
    v_readlane_b32 s47, v210, 63
    v_readlane_b32 s48, v211, 63
    v_sub_u32 v214, v210, v208
    v_add_u32 v211, s47, v211
    v_add_u32 v214, v214, v206
    v_sub_u32 v215, v211, v209
    v_add_u32 v215, v215, v207
    v_sub_u32 v216, v214, v204
    v_sub_u32 v217, v215, v205
    ds_write2st64_b32 v218, v216, v217 offset0:2 offset1:3
    s_add_u32 s47, s47, s48
    s_cmp_gt_u32 s47, 2976
    s_cselect_b32 s47, 1, 0
    s_cmp_lg_u32 s49, 0
    s_cselect_b32 s47, 1, s47
    s_cmp_gt_u32 s47, s31
    s_cbranch_scc1 K2_GOSLOW
    ds_read_b32 v96, v96 offset:512
    ds_read_b32 v97, v97 offset:512
    ds_read_b32 v98, v98 offset:512
    ds_read_b32 v99, v99 offset:512
    ds_read_b32 v100, v100 offset:512
    ds_read_b32 v101, v101 offset:512
    ds_read_b32 v102, v102 offset:512
    ds_read_b32 v103, v103 offset:512
    s_cmp_lg_u32 s31, 0
    s_cbranch_scc1 K2_NO2C
    s_mov_b32 s47, 960000
    s_or_b64 exec, s[68:69], 1
    buffer_load_dwordx4 v[24:27], v118, s[16:19], s47 offen
    s_mov_b64 exec, -1
    s_mov_b32 s47, 1120000
    s_or_b64 exec, s[70:71], 1
    buffer_load_dwordx4 v[28:31], v119, s[16:19], s47 offen
    s_mov_b64 exec, -1
    s_cmp_eq_u64 s[52:53], 0
    s_cbranch_scc1 K2_NO2C
    s_waitcnt lgkmcnt(4)
    s_mov_b64 exec, s[72:73]
    s_cbranch_execz K2_NR20
    s_mov_b32 s47, 0
    buffer_load_dwordx4 v[32:35], v112, s[16:19], s47 offen offset:240
    ds_read_b32 v104, v104 offset:512
K2_NR20:
    s_mov_b64 exec, s[74:75]
    s_cbranch_execz K2_NR21
    s_mov_b32 s47, 160000
    buffer_load_dwordx4 v[36:39], v113, s[16:19], s47 offen offset:240
    ds_read_b32 v105, v105 offset:512
K2_NR21:
    s_mov_b64 exec, s[76:77]
    s_cbranch_execz K2_NR22
    s_mov_b32 s47, 320000
    buffer_load_dwordx4 v[40:43], v114, s[16:19], s47 offen offset:240
    ds_read_b32 v106, v106 offset:512
K2_NR22:
    s_mov_b64 exec, s[78:79]
    s_cbranch_execz K2_NR23
    s_mov_b32 s47, 480000
    buffer_load_dwordx4 v[44:47], v115, s[16:19], s47 offen offset:240
    ds_read_b32 v107, v107 offset:512
K2_NR23:
    s_mov_b64 exec, s[80:81]
    s_cbranch_execz K2_NR24
    s_mov_b32 s47, 640000
    buffer_load_dwordx4 v[48:51], v116, s[16:19], s47 offen offset:240
    ds_read_b32 v108, v108 offset:512
K2_NR24:
    s_mov_b64 exec, s[82:83]
    s_cbranch_execz K2_NR25
    s_mov_b32 s47, 800000
    buffer_load_dwordx4 v[52:55], v117, s[16:19], s47 offen offset:240
    ds_read_b32 v109, v109 offset:512
K2_NR25:
    s_mov_b64 exec, s[84:85]
    s_cbranch_execz K2_NR26
    s_mov_b32 s47, 960000
    buffer_load_dwordx4 v[56:59], v118, s[16:19], s47 offen offset:240
    ds_read_b32 v110, v110 offset:512
K2_NR26:
    s_mov_b64 exec, s[86:87]
    s_cbranch_execz K2_NR27
    s_mov_b32 s47, 1120000
    buffer_load_dwordx4 v[60:63], v119, s[16:19], s47 offen offset:240
    ds_read_b32 v111, v111 offset:512
K2_NR27:
    s_mov_b64 exec, -1
K2_NO2C:
    s_cmp_lt_u32 s30, 4
    s_cselect_b64 vcc, -1, 0
    v_cndmask_b32 v214, v215, v214, vcc
    v_cndmask_b32 v210, v211, v210, vcc
    v_cndmask_b32 v212, v213, v212, vcc
    v_cndmask_b32 v208, v209, v208, vcc
    s_and_b32 s37, s30, 3
    s_lshl_b32 s37, s37, 4
    s_nop 0
    v_readlane_b32 s47, v210, s37
    v_readlane_b32 s48, v212, s37
    v_readlane_b32 s49, v208, s37
    v_and_b32 v216, 15, v125
    v_cmp_le_u32 vcc, 5, v216
    v_mov_b32 v216, 0x7fffffff
    s_sub_u32 s47, s47, s48
    s_sub_u32 s39, s48, s49
    s_lshr_b32 s34, s48, 4
    v_subrev_u32 v253, s47, v214
    v_cndmask_b32 v253, v253, v216, vcc
    v_lshrrev_b32 v248, 1, v125
    v_add_u32 v248, s47, v248
    v_lshlrev_b32 v248, 4, v248
    s_mul_i32 s47, s30, 3456
    s_add_u32 s47, s47, 49152
    s_add_u32 s48, s47, 1024
    v_lshrrev_b32 v216, 5, v125
    v_bfe_u32 v217, v125, 2, 2
    v_lshl_add_u32 v217, v216, 3, v217
    v_bfe_u32 v204, v125, 1, 1
    v_bfe_u32 v205, v125, 4, 1
    v_lshl_add_u32 v204, v205, 1, v204
    v_lshl_add_u32 v204, v204, 3, s47
    v_lshl_add_u32 v246, v217, 5, v204
    v_lshl_add_u32 v247, v216, 4, s48
    v_lshl_add_u32 v249, v125, 4, s47
    v_lshrrev_b32 v216, 1, v125
    v_lshl_add_u32 v250, v216, 2, s48
    s_mul_i32 s47, s30, 1440
    s_add_u32 s47, s47, 78912
    v_lshl_add_u32 v139, v125, 2, s47
    s_add_u32 s47, s47, 1024
    v_lshl_add_u32 v140, v125, 1, s47
    s_mul_i32 s47, s28, 40
    s_add_u32 s47, s47, s30
    s_mul_i32 s47, s47, 2816
    s_add_u32 s47, s47, 13285376
    v_lshl_add_u32 v141, v125, 2, s47
    s_waitcnt lgkmcnt(0)
    v_add_lshl_u32 v96, v96, v80, 4
    v_add_lshl_u32 v97, v97, v81, 4
    v_add_lshl_u32 v98, v98, v82, 4
    v_add_lshl_u32 v99, v99, v83, 4
    v_add_lshl_u32 v100, v100, v84, 4
    v_add_lshl_u32 v101, v101, v85, 4
    v_add_lshl_u32 v102, v102, v86, 4
    v_add_lshl_u32 v103, v103, v87, 4
    s_mov_b64 exec, s[56:57]
    s_waitcnt vmcnt(7)
    ds_write_b128 v96, v[0:3] offset:0
    s_mov_b64 exec, s[58:59]
    s_waitcnt vmcnt(6)
    ds_write_b128 v97, v[4:7] offset:0
    s_mov_b64 exec, s[60:61]
    s_waitcnt vmcnt(5)
    ds_write_b128 v98, v[8:11] offset:0
    s_mov_b64 exec, s[62:63]
    s_waitcnt vmcnt(4)
    ds_write_b128 v99, v[12:15] offset:0
    s_mov_b64 exec, s[64:65]
    s_waitcnt vmcnt(3)
    ds_write_b128 v100, v[16:19] offset:0
    s_mov_b64 exec, s[66:67]
    s_waitcnt vmcnt(2)
    ds_write_b128 v101, v[20:23] offset:0
    s_mov_b64 exec, -1
    s_lshr_b32 s47, s2, 3
    s_lshl_b32 s47, s47, 3
    s_add_u32 s47, s47, s30
    s_lshl_b32 s47, s47, 13
    v_lshl_add_u32 v143, v125, 7, s47
    s_mov_b64 exec, 0xffffffff
    buffer_load_dword v143, v143, s[12:15], 0 offen
    s_mov_b64 exec, s[68:69]
    s_waitcnt vmcnt(2)
    ds_write_b128 v102, v[24:27] offset:0
    s_mov_b64 exec, s[70:71]
    s_waitcnt vmcnt(1)
    ds_write_b128 v103, v[28:31] offset:0
    s_waitcnt vmcnt(1)
    s_cmp_eq_u64 s[52:53], 0
    s_cbranch_scc1 K2_NO2D
    s_mov_b64 exec, s[72:73]
    s_cbranch_execz K2_NS20
    v_add_lshl_u32 v104, v104, v88, 4
    ds_write_b128 v104, v[32:35] offset:0
K2_NS20:
    s_mov_b64 exec, s[74:75]
    s_cbranch_execz K2_NS21
    v_add_lshl_u32 v105, v105, v89, 4
    ds_write_b128 v105, v[36:39] offset:0
K2_NS21:
    s_mov_b64 exec, s[76:77]
    s_cbranch_execz K2_NS22
    v_add_lshl_u32 v106, v106, v90, 4
    ds_write_b128 v106, v[40:43] offset:0
K2_NS22:
    s_mov_b64 exec, s[78:79]
    s_cbranch_execz K2_NS23
    v_add_lshl_u32 v107, v107, v91, 4
    ds_write_b128 v107, v[44:47] offset:0
K2_NS23:
    s_mov_b64 exec, s[80:81]
    s_cbranch_execz K2_NS24
    v_add_lshl_u32 v108, v108, v92, 4
    ds_write_b128 v108, v[48:51] offset:0
K2_NS24:
    s_mov_b64 exec, s[82:83]
    s_cbranch_execz K2_NS25
    v_add_lshl_u32 v109, v109, v93, 4
    ds_write_b128 v109, v[52:55] offset:0
K2_NS25:
    s_mov_b64 exec, s[84:85]
    s_cbranch_execz K2_NS26
    v_add_lshl_u32 v110, v110, v94, 4
    ds_write_b128 v110, v[56:59] offset:0
K2_NS26:
    s_mov_b64 exec, s[86:87]
    s_cbranch_execz K2_NS27
    v_add_lshl_u32 v111, v111, v95, 4
    ds_write_b128 v111, v[60:63] offset:0
K2_NS27:
K2_NO2D:
    s_mov_b64 exec, -1
    v_lshlrev_b32 v128, 4, v125
    v_add_u32 v128, 136512, v128
    s_cmp_lg_u32 s31, 0
    s_cbranch_scc1 K2_NOWST
    ds_write_b128 v188, v[184:187]
K2_NOWST:
    s_waitcnt lgkmcnt(0)
    s_barrier
    s_cmp_eq_u32 s34, 0
    s_cbranch_scc1 K2_EMPTY
    ds_read_b128 v[240:243], v248
    ds_read_b128 v[204:207], v248 offset:512
    s_setprio 3
    s_mov_b32 s44, 1152
    s_mov_b32 s45, 1152
    s_mov_b32 s46, -2304
    v_mfma_f32_32x32x8_bf16 v[64:79], v[244:245], v[244:245], 0
    v_mfma_f32_32x32x8_bf16 v[80:95], v[244:245], v[244:245], 0
    v_mfma_f32_32x32x8_bf16 v[96:111], v[244:245], v[244:245], 0
    v_mfma_f32_32x32x8_bf16 v[112:127], v[244:245], v[244:245], 0
    s_waitcnt lgkmcnt(1)
    v_bitop3_b32 v232, v254, v241, v240 bitop3:0xca
    v_lshlrev_b32 v222, 16, v242
    v_lshlrev_b32 v220, 16, v232
    v_and_b32 v221, 0xffff0000, v232
    v_and_b32 v223, 0xffff0000, v242
    v_lshlrev_b32 v224, 16, v243
    v_mul_f32 v225, v220, v222
    v_mul_f32 v226, v221, v222
    v_cvt_pk_bf16_f32 v233, v225, v226
    v_mul_f32 v225, v220, v223
    v_mul_f32 v226, v221, v223
    v_cvt_pk_bf16_f32 v234, v225, v226
    v_mul_f32 v225, v220, v224
    v_mul_f32 v226, v221, v224
    v_cvt_pk_bf16_f32 v235, v225, v226
    v_lshrrev_b32 v227, 7, v243
    v_and_b32 v227, 0x1fffe00, v227
    ds_write_b128 v249, v[232:235] offset:0
    ds_write_b32 v250, v227 offset:0
    ds_read_b128 v[212:215], v247
    ds_read_b128 v[216:219], v247 offset:32
    ds_read_b128 v[220:223], v247 offset:64
    ds_read_b128 v[224:227], v247 offset:96
    v_add_u32 v248, 1024, v248
    v_add_u32 v247, 1152, v247
    s_waitcnt lgkmcnt(2)
    v_add_u32 v212, v212, v251
    v_add_u32 v213, v213, v251
    v_add_u32 v214, v214, v251
    v_add_u32 v215, v215, v251
    v_add_u32 v216, v216, v251
    v_add_u32 v217, v217, v251
    v_add_u32 v218, v218, v251
    v_add_u32 v219, v219, v251
    s_cmp_gt_u32 s39, 4
    s_cbranch_scc1 K2_IZ0
    buffer_load_dword v0, v212, s[12:15], 0 offen offset:0
    buffer_load_dword v8, v212, s[12:15], 0 offen offset:128
    buffer_load_dword v16, v212, s[12:15], 0 offen offset:256
    buffer_load_dword v24, v212, s[12:15], 0 offen offset:384
K2_IN0:
    s_cmp_gt_u32 s39, 5
    s_cbranch_scc1 K2_IZ1
    buffer_load_dword v1, v213, s[12:15], 0 offen offset:0
    buffer_load_dword v9, v213, s[12:15], 0 offen offset:128
    buffer_load_dword v17, v213, s[12:15], 0 offen offset:256
    buffer_load_dword v25, v213, s[12:15], 0 offen offset:384
K2_IN1:
    s_cmp_gt_u32 s39, 6
    s_cbranch_scc1 K2_IZ2
    buffer_load_dword v2, v214, s[12:15], 0 offen offset:0
    buffer_load_dword v10, v214, s[12:15], 0 offen offset:128
    buffer_load_dword v18, v214, s[12:15], 0 offen offset:256
    buffer_load_dword v26, v214, s[12:15], 0 offen offset:384
K2_IN2:
    s_cmp_gt_u32 s39, 7
    s_cbranch_scc1 K2_IZ3
    buffer_load_dword v3, v215, s[12:15], 0 offen offset:0
    buffer_load_dword v11, v215, s[12:15], 0 offen offset:128
    buffer_load_dword v19, v215, s[12:15], 0 offen offset:256
    buffer_load_dword v27, v215, s[12:15], 0 offen offset:384
K2_IN3:
    s_cmp_gt_u32 s39, 12
    s_cbranch_scc1 K2_IZ4
    buffer_load_dword v4, v216, s[12:15], 0 offen offset:0
    buffer_load_dword v12, v216, s[12:15], 0 offen offset:128
    buffer_load_dword v20, v216, s[12:15], 0 offen offset:256
    buffer_load_dword v28, v216, s[12:15], 0 offen offset:384
K2_IN4:
    s_cmp_gt_u32 s39, 13
    s_cbranch_scc1 K2_IZ5
    buffer_load_dword v5, v217, s[12:15], 0 offen offset:0
    buffer_load_dword v13, v217, s[12:15], 0 offen offset:128
    buffer_load_dword v21, v217, s[12:15], 0 offen offset:256
    buffer_load_dword v29, v217, s[12:15], 0 offen offset:384
K2_IN5:
    s_cmp_gt_u32 s39, 14
    s_cbranch_scc1 K2_IZ6
    buffer_load_dword v6, v218, s[12:15], 0 offen offset:0
    buffer_load_dword v14, v218, s[12:15], 0 offen offset:128
    buffer_load_dword v22, v218, s[12:15], 0 offen offset:256
    buffer_load_dword v30, v218, s[12:15], 0 offen offset:384
K2_IN6:
    buffer_load_dword v7, v219, s[12:15], 0 offen offset:0
    buffer_load_dword v15, v219, s[12:15], 0 offen offset:128
    buffer_load_dword v23, v219, s[12:15], 0 offen offset:256
    buffer_load_dword v31, v219, s[12:15], 0 offen offset:384
K2_IN7:
    s_cmp_eq_u32 s34, 1
    s_cbranch_scc1 K2_INITD
    s_waitcnt lgkmcnt(0)
    v_add_u32 v220, v220, v251
    v_add_u32 v221, v221, v251
    v_add_u32 v222, v222, v251
    v_add_u32 v223, v223, v251
    v_add_u32 v224, v224, v251
    v_add_u32 v225, v225, v251
    v_add_u32 v226, v226, v251
    v_add_u32 v227, v227, v251
    buffer_load_dword v32, v220, s[12:15], 0 offen offset:0
    buffer_load_dword v33, v221, s[12:15], 0 offen offset:0
    buffer_load_dword v34, v222, s[12:15], 0 offen offset:0
    buffer_load_dword v35, v223, s[12:15], 0 offen offset:0
    buffer_load_dword v36, v224, s[12:15], 0 offen offset:0
    buffer_load_dword v37, v225, s[12:15], 0 offen offset:0
    buffer_load_dword v38, v226, s[12:15], 0 offen offset:0
    buffer_load_dword v39, v227, s[12:15], 0 offen offset:0
    buffer_load_dword v40, v220, s[12:15], 0 offen offset:128
    buffer_load_dword v41, v221, s[12:15], 0 offen offset:128
    buffer_load_dword v42, v222, s[12:15], 0 offen offset:128
    buffer_load_dword v43, v223, s[12:15], 0 offen offset:128
    buffer_load_dword v44, v224, s[12:15], 0 offen offset:128
    buffer_load_dword v45, v225, s[12:15], 0 offen offset:128
    buffer_load_dword v46, v226, s[12:15], 0 offen offset:128
    buffer_load_dword v47, v227, s[12:15], 0 offen offset:128
    buffer_load_dword v48, v220, s[12:15], 0 offen offset:256
    buffer_load_dword v49, v221, s[12:15], 0 offen offset:256
    buffer_load_dword v50, v222, s[12:15], 0 offen offset:256
    buffer_load_dword v51, v223, s[12:15], 0 offen offset:256
    buffer_load_dword v52, v224, s[12:15], 0 offen offset:256
    buffer_load_dword v53, v225, s[12:15], 0 offen offset:256
    buffer_load_dword v54, v226, s[12:15], 0 offen offset:256
    buffer_load_dword v55, v227, s[12:15], 0 offen offset:256
    s_waitcnt vmcnt(55)
    buffer_load_dword v56, v220, s[12:15], 0 offen offset:384
    buffer_load_dword v57, v221, s[12:15], 0 offen offset:384
    buffer_load_dword v58, v222, s[12:15], 0 offen offset:384
    buffer_load_dword v59, v223, s[12:15], 0 offen offset:384
    buffer_load_dword v60, v224, s[12:15], 0 offen offset:384
    buffer_load_dword v61, v225, s[12:15], 0 offen offset:384
    buffer_load_dword v62, v226, s[12:15], 0 offen offset:384
    buffer_load_dword v63, v227, s[12:15], 0 offen offset:384
K2_INITD:
    s_waitcnt lgkmcnt(0)
    v_bitop3_b32 v232, v254, v205, v204 bitop3:0xca
    v_lshlrev_b32 v222, 16, v206
    v_lshlrev_b32 v220, 16, v232
    v_and_b32 v221, 0xffff0000, v232
    v_and_b32 v223, 0xffff0000, v206
    v_lshlrev_b32 v224, 16, v207
    v_mul_f32 v225, v220, v222
    v_mul_f32 v226, v221, v222
    v_cvt_pk_bf16_f32 v233, v225, v226
    v_mul_f32 v225, v220, v223
    v_mul_f32 v226, v221, v223
    v_cvt_pk_bf16_f32 v234, v225, v226
    v_mul_f32 v225, v220, v224
    v_mul_f32 v226, v221, v224
    v_cvt_pk_bf16_f32 v235, v225, v226
    v_lshrrev_b32 v227, 7, v207
    v_and_b32 v227, 0x1fffe00, v227
    ds_write_b128 v249, v[232:235] offset:1152
    ds_write_b32 v250, v227 offset:1152
    v_add_u32 v249, 2304, v249
    v_add_u32 v250, 2304, v250
    ds_read_b128 v[184:187], v128 offset:0
    ds_read_b128 v[188:191], v128 offset:1024
    ds_read_b128 v[192:195], v128 offset:2048
    ds_read_b128 v[196:199], v128 offset:3072
    ds_read_b128 v[200:203], v128 offset:4096
    v_readlane_b32 s54, v253, s37
    ds_read_b64_tr_b16 v[204:205], v246
    ds_read_b64_tr_b16 v[206:207], v246 offset:128
    ds_read_b128 v[212:215], v247
    ds_read_b128 v[216:219], v247 offset:32
    s_mov_b32 s35, 0
    s_mov_b32 s36, 0
.p2align 3
K2_LOOP:
    ds_read_b128 v[240:243], v248
    ds_read_b64_tr_b16 v[208:209], v246 offset:512
    ds_read_b64_tr_b16 v[210:211], v246 offset:640
    ds_read_b128 v[220:223], v247 offset:64
    ds_read_b128 v[224:227], v247 offset:96
    s_sub_u32 s36, s36, 1
    s_waitcnt lgkmcnt(5)
    v_add_u32 v212, v212, v251
    v_add_u32 v213, v213, v251
    v_add_u32 v214, v214, v251
    v_add_u32 v215, v215, v251
    v_add_u32 v216, v216, v251
    v_add_u32 v217, v217, v251
    v_add_u32 v218, v218, v251
    v_add_u32 v219, v219, v251
    s_cbranch_scc1 K2_SP0
    s_waitcnt vmcnt(55)
    v_smfmac_f32_32x32x32_bf16 v[64:79], v[204:207], v[0:7], v255
    buffer_load_dword v0, v212, s[12:15], 0 offen offset:0
    buffer_load_dword v1, v213, s[12:15], 0 offen offset:0
    buffer_load_dword v2, v214, s[12:15], 0 offen offset:0
    buffer_load_dword v3, v215, s[12:15], 0 offen offset:0
    buffer_load_dword v4, v216, s[12:15], 0 offen offset:0
    buffer_load_dword v5, v217, s[12:15], 0 offen offset:0
    buffer_load_dword v6, v218, s[12:15], 0 offen offset:0
    buffer_load_dword v7, v219, s[12:15], 0 offen offset:0
    s_waitcnt vmcnt(55)
    v_smfmac_f32_32x32x32_bf16 v[80:95], v[204:207], v[8:15], v255
    buffer_load_dword v8, v212, s[12:15], 0 offen offset:128
    buffer_load_dword v9, v213, s[12:15], 0 offen offset:128
    buffer_load_dword v10, v214, s[12:15], 0 offen offset:128
    buffer_load_dword v11, v215, s[12:15], 0 offen offset:128
    buffer_load_dword v12, v216, s[12:15], 0 offen offset:128
    buffer_load_dword v13, v217, s[12:15], 0 offen offset:128
    buffer_load_dword v14, v218, s[12:15], 0 offen offset:128
    buffer_load_dword v15, v219, s[12:15], 0 offen offset:128
    s_waitcnt vmcnt(55)
    v_smfmac_f32_32x32x32_bf16 v[96:111], v[204:207], v[16:23], v255
    buffer_load_dword v16, v212, s[12:15], 0 offen offset:256
    buffer_load_dword v17, v213, s[12:15], 0 offen offset:256
    buffer_load_dword v18, v214, s[12:15], 0 offen offset:256
    buffer_load_dword v19, v215, s[12:15], 0 offen offset:256
    buffer_load_dword v20, v216, s[12:15], 0 offen offset:256
    buffer_load_dword v21, v217, s[12:15], 0 offen offset:256
    buffer_load_dword v22, v218, s[12:15], 0 offen offset:256
    buffer_load_dword v23, v219, s[12:15], 0 offen offset:256
    s_waitcnt vmcnt(55)
    v_smfmac_f32_32x32x32_bf16 v[112:127], v[204:207], v[24:31], v255
    buffer_load_dword v24, v212, s[12:15], 0 offen offset:384
    buffer_load_dword v25, v213, s[12:15], 0 offen offset:384
    buffer_load_dword v26, v214, s[12:15], 0 offen offset:384
    buffer_load_dword v27, v215, s[12:15], 0 offen offset:384
    buffer_load_dword v28, v216, s[12:15], 0 offen offset:384
    buffer_load_dword v29, v217, s[12:15], 0 offen offset:384
    buffer_load_dword v30, v218, s[12:15], 0 offen offset:384
    buffer_load_dword v31, v219, s[12:15], 0 offen offset:384
K2_NEXT0:
    s_waitcnt lgkmcnt(4)
    v_bitop3_b32 v232, v254, v241, v240 bitop3:0xca
    v_lshlrev_b32 v214, 16, v242
    v_lshlrev_b32 v212, 16, v232
    v_and_b32 v213, 0xffff0000, v232
    v_and_b32 v215, 0xffff0000, v242
    v_lshlrev_b32 v216, 16, v243
    v_mul_f32 v217, v212, v214
    v_mul_f32 v218, v213, v214
    v_cvt_pk_bf16_f32 v233, v217, v218
    v_mul_f32 v217, v212, v215
    v_mul_f32 v218, v213, v215
    v_cvt_pk_bf16_f32 v234, v217, v218
    v_mul_f32 v217, v212, v216
    v_mul_f32 v218, v213, v216
    v_cvt_pk_bf16_f32 v235, v217, v218
    v_lshrrev_b32 v219, 7, v243
    v_and_b32 v219, 0x1fffe00, v219
    ds_write_b128 v249, v[232:235] offset:0
    ds_write_b32 v250, v219 offset:0
    v_add_u32 v248, 512, v248
    v_add_u32 v249, s46, v249
    v_add_u32 v250, s46, v250
    v_add_u32 v246, s44, v246
    v_add_u32 v247, s45, v247
    ds_read_b64_tr_b16 v[204:205], v246 offset:0
    ds_read_b64_tr_b16 v[206:207], v246 offset:128
    ds_read_b128 v[212:215], v247 offset:0
    ds_read_b128 v[216:219], v247 offset:32
    s_sub_u32 s36, s36, 1
    s_waitcnt lgkmcnt(4)
    v_add_u32 v220, v220, v251
    v_add_u32 v221, v221, v251
    v_add_u32 v222, v222, v251
    v_add_u32 v223, v223, v251
    v_add_u32 v224, v224, v251
    v_add_u32 v225, v225, v251
    v_add_u32 v226, v226, v251
    v_add_u32 v227, v227, v251
    s_cbranch_scc1 K2_SP1
    s_waitcnt vmcnt(55)
    v_smfmac_f32_32x32x32_bf16 v[64:79], v[208:211], v[32:39], v255
    buffer_load_dword v32, v220, s[12:15], 0 offen offset:0
    buffer_load_dword v33, v221, s[12:15], 0 offen offset:0
    buffer_load_dword v34, v222, s[12:15], 0 offen offset:0
    buffer_load_dword v35, v223, s[12:15], 0 offen offset:0
    buffer_load_dword v36, v224, s[12:15], 0 offen offset:0
    buffer_load_dword v37, v225, s[12:15], 0 offen offset:0
    buffer_load_dword v38, v226, s[12:15], 0 offen offset:0
    buffer_load_dword v39, v227, s[12:15], 0 offen offset:0
    s_waitcnt vmcnt(55)
    v_smfmac_f32_32x32x32_bf16 v[80:95], v[208:211], v[40:47], v255
    buffer_load_dword v40, v220, s[12:15], 0 offen offset:128
    buffer_load_dword v41, v221, s[12:15], 0 offen offset:128
    buffer_load_dword v42, v222, s[12:15], 0 offen offset:128
    buffer_load_dword v43, v223, s[12:15], 0 offen offset:128
    buffer_load_dword v44, v224, s[12:15], 0 offen offset:128
    buffer_load_dword v45, v225, s[12:15], 0 offen offset:128
    buffer_load_dword v46, v226, s[12:15], 0 offen offset:128
    buffer_load_dword v47, v227, s[12:15], 0 offen offset:128
    s_waitcnt vmcnt(55)
    v_smfmac_f32_32x32x32_bf16 v[96:111], v[208:211], v[48:55], v255
    buffer_load_dword v48, v220, s[12:15], 0 offen offset:256
    buffer_load_dword v49, v221, s[12:15], 0 offen offset:256
    buffer_load_dword v50, v222, s[12:15], 0 offen offset:256
    buffer_load_dword v51, v223, s[12:15], 0 offen offset:256
    buffer_load_dword v52, v224, s[12:15], 0 offen offset:256
    buffer_load_dword v53, v225, s[12:15], 0 offen offset:256
    buffer_load_dword v54, v226, s[12:15], 0 offen offset:256
    buffer_load_dword v55, v227, s[12:15], 0 offen offset:256
    s_waitcnt vmcnt(55)
    v_smfmac_f32_32x32x32_bf16 v[112:127], v[208:211], v[56:63], v255
    buffer_load_dword v56, v220, s[12:15], 0 offen offset:384
    buffer_load_dword v57, v221, s[12:15], 0 offen offset:384
    buffer_load_dword v58, v222, s[12:15], 0 offen offset:384
    buffer_load_dword v59, v223, s[12:15], 0 offen offset:384
    buffer_load_dword v60, v224, s[12:15], 0 offen offset:384
    buffer_load_dword v61, v225, s[12:15], 0 offen offset:384
    buffer_load_dword v62, v226, s[12:15], 0 offen offset:384
    buffer_load_dword v63, v227, s[12:15], 0 offen offset:384
K2_NEXT1:
    s_mov_b32 s47, s44
    s_mov_b32 s44, s45
    s_mov_b32 s45, s46
    s_mov_b32 s46, s47
    s_branch K2_LOOP
K2_SP0:
    s_add_u32 s47, s37, 1
    v_readlane_b32 s55, v253, s47
    s_sub_u32 s43, s34, s35
    s_lshl_b32 s49, s35, 4
    s_cmp_le_u32 s43, 2
    s_cbranch_scc1 K2_GEN0
    s_cmp_le_u32 s35, s38
    s_cbranch_scc1 K2_GEN0
    s_add_u32 s48, s49, 16
    s_cmp_le_u32 s55, s48
    s_cbranch_scc1 K2_GEN0
    v_and_b32 v232, v204, v228
    v_and_b32 v233, v205, v229
    v_and_b32 v234, v206, v230
    v_and_b32 v235, v207, v231
    v_bitop3_b32 v236, v204, v228, v228 bitop3:0x30
    v_bitop3_b32 v237, v205, v229, v229 bitop3:0x30
    v_bitop3_b32 v238, v206, v230, v230 bitop3:0x30
    v_bitop3_b32 v239, v207, v231, v231 bitop3:0x30
    s_waitcnt vmcnt(31)
    v_smfmac_f32_32x32x32_bf16 v[64:79], v[232:235], v[0:7], v255
    v_smfmac_f32_32x32x32_bf16 v[80:95], v[232:235], v[8:15], v255
    v_smfmac_f32_32x32x32_bf16 v[96:111], v[232:235], v[16:23], v255
    v_smfmac_f32_32x32x32_bf16 v[112:127], v[232:235], v[24:31], v255
    s_mov_b32 s37, s47
    s_mov_b32 s54, s55
    s_sub_u32 s47, s54, 1
    s_and_b32 s40, s47, 15
    s_add_u32 s40, s40, 1
    s_lshr_b32 s47, s47, 4
    s_sub_i32 s48, s34, 2
    s_add_u32 s49, s35, 1
    s_max_i32 s48, s48, s49
    s_min_u32 s35, s47, s48
    s_sub_u32 s36, s35, s49
    s_lshl_b32 s47, s40, 5
    v_add_u32 v204, s47, v252
    ds_read_b128 v[228:231], v204
    v_mul_f32 v128, v184, v64
    v_mul_f32 v130, v192, v66
    v_mul_f32 v131, v192, v68
    v_mul_f32 v132, v192, v70
    v_fmac_f32 v128, v185, v65
    v_fmac_f32 v130, v193, v67
    v_fmac_f32 v131, v193, v69
    v_fmac_f32 v132, v193, v71
    v_fmac_f32 v128, v186, v72
    v_fmac_f32 v130, v194, v74
    v_fmac_f32 v131, v194, v76
    v_fmac_f32 v132, v194, v78
    v_fmac_f32 v128, v187, v73
    v_fmac_f32 v130, v195, v75
    v_fmac_f32 v131, v195, v77
    v_fmac_f32 v132, v195, v79
    v_mfma_f32_32x32x8_bf16 v[64:79], v[244:245], v[244:245], 0
    v_smfmac_f32_32x32x32_bf16 v[64:79], v[236:239], v[0:7], v255
    buffer_load_dword v0, v212, s[12:15], 0 offen offset:0
    buffer_load_dword v1, v213, s[12:15], 0 offen offset:0
    buffer_load_dword v2, v214, s[12:15], 0 offen offset:0
    buffer_load_dword v3, v215, s[12:15], 0 offen offset:0
    buffer_load_dword v4, v216, s[12:15], 0 offen offset:0
    buffer_load_dword v5, v217, s[12:15], 0 offen offset:0
    buffer_load_dword v6, v218, s[12:15], 0 offen offset:0
    buffer_load_dword v7, v219, s[12:15], 0 offen offset:0
    v_mul_f32 v133, v196, v80
    v_mul_f32 v129, v188, v82
    v_mul_f32 v138, -v200, v84
    v_mul_f32 v137, v200, v86
    v_fmac_f32 v133, v197, v81
    v_fmac_f32 v129, v189, v83
    v_fma_f32 v138, -v201, v85, v138
    v_fmac_f32 v137, v201, v87
    v_fmac_f32 v133, v198, v88
    v_fmac_f32 v129, v190, v90
    v_fma_f32 v138, -v202, v92, v138
    v_fmac_f32 v137, v202, v94
    v_fmac_f32 v133, v199, v89
    v_fmac_f32 v129, v191, v91
    v_fma_f32 v138, -v203, v93, v138
    v_fmac_f32 v137, v203, v95
    v_mfma_f32_32x32x8_bf16 v[80:95], v[244:245], v[244:245], 0
    v_smfmac_f32_32x32x32_bf16 v[80:95], v[236:239], v[8:15], v255
    buffer_load_dword v8, v212, s[12:15], 0 offen offset:128
    buffer_load_dword v9, v213, s[12:15], 0 offen offset:128
    buffer_load_dword v10, v214, s[12:15], 0 offen offset:128
    buffer_load_dword v11, v215, s[12:15], 0 offen offset:128
    buffer_load_dword v12, v216, s[12:15], 0 offen offset:128
    buffer_load_dword v13, v217, s[12:15], 0 offen offset:128
    buffer_load_dword v14, v218, s[12:15], 0 offen offset:128
    buffer_load_dword v15, v219, s[12:15], 0 offen offset:128
    v_mul_f32 v134, v196, v96
    v_fmac_f32 v138, v200, v98
    v_fmac_f32 v129, v188, v100
    v_mul_f32 v136, -v200, v102
    v_fmac_f32 v134, v197, v97
    v_fmac_f32 v138, v201, v99
    v_fmac_f32 v129, v189, v101
    v_fma_f32 v136, -v201, v103, v136
    v_fmac_f32 v134, v198, v104
    v_fmac_f32 v138, v202, v106
    v_fmac_f32 v129, v190, v108
    v_fma_f32 v136, -v202, v110, v136
    v_fmac_f32 v134, v199, v105
    v_fmac_f32 v138, v203, v107
    v_fmac_f32 v129, v191, v109
    v_fma_f32 v136, -v203, v111, v136
    v_mfma_f32_32x32x8_bf16 v[96:111], v[244:245], v[244:245], 0
    v_smfmac_f32_32x32x32_bf16 v[96:111], v[236:239], v[16:23], v255
    buffer_load_dword v16, v212, s[12:15], 0 offen offset:256
    buffer_load_dword v17, v213, s[12:15], 0 offen offset:256
    buffer_load_dword v18, v214, s[12:15], 0 offen offset:256
    buffer_load_dword v19, v215, s[12:15], 0 offen offset:256
    buffer_load_dword v20, v216, s[12:15], 0 offen offset:256
    buffer_load_dword v21, v217, s[12:15], 0 offen offset:256
    buffer_load_dword v22, v218, s[12:15], 0 offen offset:256
    buffer_load_dword v23, v219, s[12:15], 0 offen offset:256
    v_mul_f32 v135, v196, v112
    v_fma_f32 v137, -v200, v114, v137
    v_fmac_f32 v136, v200, v116
    v_fmac_f32 v129, v188, v118
    v_fmac_f32 v135, v197, v113
    v_fma_f32 v137, -v201, v115, v137
    v_fmac_f32 v136, v201, v117
    v_fmac_f32 v129, v189, v119
    v_fmac_f32 v135, v198, v120
    v_fma_f32 v137, -v202, v122, v137
    v_fmac_f32 v136, v202, v124
    v_fmac_f32 v129, v190, v126
    v_fmac_f32 v135, v199, v121
    v_fma_f32 v137, -v203, v123, v137
    v_fmac_f32 v136, v203, v125
    v_fmac_f32 v129, v191, v127
    v_mfma_f32_32x32x8_bf16 v[112:127], v[244:245], v[244:245], 0
    v_smfmac_f32_32x32x32_bf16 v[112:127], v[236:239], v[24:31], v255
    buffer_load_dword v24, v212, s[12:15], 0 offen offset:384
    buffer_load_dword v25, v213, s[12:15], 0 offen offset:384
    buffer_load_dword v26, v214, s[12:15], 0 offen offset:384
    buffer_load_dword v27, v215, s[12:15], 0 offen offset:384
    buffer_load_dword v28, v216, s[12:15], 0 offen offset:384
    buffer_load_dword v29, v217, s[12:15], 0 offen offset:384
    buffer_load_dword v30, v218, s[12:15], 0 offen offset:384
    buffer_load_dword v31, v219, s[12:15], 0 offen offset:384
    v_cvt_pk_bf16_f32 v232, v128, v129
    v_cvt_pk_bf16_f32 v233, v130, v133
    v_cvt_pk_bf16_f32 v234, v131, v134
    v_cvt_pk_bf16_f32 v235, v132, v135
    v_cvt_pk_bf16_f32 v236, v136, v137
    v_cvt_pk_bf16_f32 v237, v138, v138
    ds_write2st64_b32 v139, v232, v233 offset0:0 offset1:1
    ds_write2st64_b32 v139, v234, v235 offset0:2 offset1:3
    ds_write_b16 v140, v236
    ds_write_b16_d16_hi v140, v236 offset:128
    ds_write_b16 v140, v237 offset:256
    v_add_u32 v139, 11520, v139
    v_add_u32 v140, 11520, v140
    s_and_b32 s47, s37, 15
    s_cmp_lg_u32 s47, 4
    s_cbranch_scc1 K2_PR1
    v_mov_b32 v238, 78856
    v_mov_b32 v239, 1
    s_mov_b64 exec, 1
    ds_add_u32 v238, v239
    s_mov_b64 exec, -1
K2_PR1:
    s_and_b32 s47, s37, 15
    s_cmp_lg_u32 s47, 2
    s_cbranch_scc1 K2_PR2
    s_setprio 2
K2_PR2:
    s_cmp_lg_u32 s47, 3
    s_cbranch_scc1 K2_PR3
    s_setprio 1
K2_PR3:
    s_cmp_lg_u32 s47, 4
    s_cbranch_scc1 K2_PR4
    s_setprio 0
K2_PR4:
    s_branch K2_NEXT0
K2_GEN0:
    s_cmp_ge_u32 s43, 2
    s_cbranch_scc1 K2_GW0
    s_waitcnt vmcnt(0)
K2_GW0:
    s_cmp_eq_u32 s35, 0
    s_cselect_b32 s39, s39, 0
K2_GL0:
    s_sub_u32 s41, s54, s49
    s_min_u32 s40, s41, 16
    s_lshl_b32 s47, s40, 5
    v_add_u32 v232, s47, v252
    ds_read_b128 v[228:231], v232
    s_lshl_b32 s47, s39, 5
    v_add_u32 v233, s47, v252
    ds_read_b128 v[236:239], v233
    s_waitcnt vmcnt(31) lgkmcnt(0)
    v_bitop3_b32 v232, v204, v228, v236 bitop3:0x40
    v_bitop3_b32 v233, v205, v229, v237 bitop3:0x40
    v_bitop3_b32 v234, v206, v230, v238 bitop3:0x40
    v_bitop3_b32 v235, v207, v231, v239 bitop3:0x40
    s_nop 1
    v_smfmac_f32_32x32x32_bf16 v[64:79], v[232:235], v[0:7], v255
    v_smfmac_f32_32x32x32_bf16 v[80:95], v[232:235], v[8:15], v255
    v_smfmac_f32_32x32x32_bf16 v[96:111], v[232:235], v[16:23], v255
    v_smfmac_f32_32x32x32_bf16 v[112:127], v[232:235], v[24:31], v255
    s_cmp_gt_u32 s41, 16
    s_cbranch_scc1 K2_GD0
    s_mov_b32 s42, 0
    s_branch K2_EPI
K2_GD0:
    s_cmp_le_u32 s43, 2
    s_cbranch_scc1 K2_NL0
    buffer_load_dword v0, v212, s[12:15], 0 offen offset:0
    buffer_load_dword v1, v213, s[12:15], 0 offen offset:0
    buffer_load_dword v2, v214, s[12:15], 0 offen offset:0
    buffer_load_dword v3, v215, s[12:15], 0 offen offset:0
    buffer_load_dword v4, v216, s[12:15], 0 offen offset:0
    buffer_load_dword v5, v217, s[12:15], 0 offen offset:0
    buffer_load_dword v6, v218, s[12:15], 0 offen offset:0
    buffer_load_dword v7, v219, s[12:15], 0 offen offset:0
    buffer_load_dword v8, v212, s[12:15], 0 offen offset:128
    buffer_load_dword v9, v213, s[12:15], 0 offen offset:128
    buffer_load_dword v10, v214, s[12:15], 0 offen offset:128
    buffer_load_dword v11, v215, s[12:15], 0 offen offset:128
    buffer_load_dword v12, v216, s[12:15], 0 offen offset:128
    buffer_load_dword v13, v217, s[12:15], 0 offen offset:128
    buffer_load_dword v14, v218, s[12:15], 0 offen offset:128
    buffer_load_dword v15, v219, s[12:15], 0 offen offset:128
    buffer_load_dword v16, v212, s[12:15], 0 offen offset:256
    buffer_load_dword v17, v213, s[12:15], 0 offen offset:256
    buffer_load_dword v18, v214, s[12:15], 0 offen offset:256
    buffer_load_dword v19, v215, s[12:15], 0 offen offset:256
    buffer_load_dword v20, v216, s[12:15], 0 offen offset:256
    buffer_load_dword v21, v217, s[12:15], 0 offen offset:256
    buffer_load_dword v22, v218, s[12:15], 0 offen offset:256
    buffer_load_dword v23, v219, s[12:15], 0 offen offset:256
    buffer_load_dword v24, v212, s[12:15], 0 offen offset:384
    buffer_load_dword v25, v213, s[12:15], 0 offen offset:384
    buffer_load_dword v26, v214, s[12:15], 0 offen offset:384
    buffer_load_dword v27, v215, s[12:15], 0 offen offset:384
    buffer_load_dword v28, v216, s[12:15], 0 offen offset:384
    buffer_load_dword v29, v217, s[12:15], 0 offen offset:384
    buffer_load_dword v30, v218, s[12:15], 0 offen offset:384
    buffer_load_dword v31, v219, s[12:15], 0 offen offset:384
K2_NL0:
    s_cmp_eq_u32 s43, 1
    s_cbranch_scc1 K2_STREAM_DONE
    s_sub_u32 s47, s54, 1
    s_and_b32 s40, s47, 15
    s_add_u32 s40, s40, 1
    s_lshr_b32 s47, s47, 4
    s_sub_i32 s48, s34, 2
    s_add_u32 s49, s35, 1
    s_max_i32 s48, s48, s49
    s_min_u32 s35, s47, s48
    s_sub_u32 s36, s35, s49
    s_lshl_b32 s47, s40, 5
    v_add_u32 v232, s47, v252
    ds_read_b128 v[228:231], v232
    s_branch K2_NEXT0
K2_SP1:
    s_add_u32 s47, s37, 1
    v_readlane_b32 s55, v253, s47
    s_sub_u32 s43, s34, s35
    s_lshl_b32 s49, s35, 4
    s_cmp_le_u32 s43, 2
    s_cbranch_scc1 K2_GEN1
    s_cmp_le_u32 s35, s38
    s_cbranch_scc1 K2_GEN1
    s_add_u32 s48, s49, 16
    s_cmp_le_u32 s55, s48
    s_cbranch_scc1 K2_GEN1
    v_and_b32 v232, v208, v228
    v_and_b32 v233, v209, v229
    v_and_b32 v234, v210, v230
    v_and_b32 v235, v211, v231
    v_bitop3_b32 v236, v208, v228, v228 bitop3:0x30
    v_bitop3_b32 v237, v209, v229, v229 bitop3:0x30
    v_bitop3_b32 v238, v210, v230, v230 bitop3:0x30
    v_bitop3_b32 v239, v211, v231, v231 bitop3:0x30
    s_waitcnt vmcnt(31)
    v_smfmac_f32_32x32x32_bf16 v[64:79], v[232:235], v[32:39], v255
    v_smfmac_f32_32x32x32_bf16 v[80:95], v[232:235], v[40:47], v255
    v_smfmac_f32_32x32x32_bf16 v[96:111], v[232:235], v[48:55], v255
    v_smfmac_f32_32x32x32_bf16 v[112:127], v[232:235], v[56:63], v255
    s_mov_b32 s37, s47
    s_mov_b32 s54, s55
    s_sub_u32 s47, s54, 1
    s_and_b32 s40, s47, 15
    s_add_u32 s40, s40, 1
    s_lshr_b32 s47, s47, 4
    s_sub_i32 s48, s34, 2
    s_add_u32 s49, s35, 1
    s_max_i32 s48, s48, s49
    s_min_u32 s35, s47, s48
    s_sub_u32 s36, s35, s49
    s_lshl_b32 s47, s40, 5
    v_add_u32 v208, s47, v252
    ds_read_b128 v[228:231], v208
    v_mul_f32 v128, v184, v64
    v_mul_f32 v130, v192, v66
    v_mul_f32 v131, v192, v68
    v_mul_f32 v132, v192, v70
    v_fmac_f32 v128, v185, v65
    v_fmac_f32 v130, v193, v67
    v_fmac_f32 v131, v193, v69
    v_fmac_f32 v132, v193, v71
    v_fmac_f32 v128, v186, v72
    v_fmac_f32 v130, v194, v74
    v_fmac_f32 v131, v194, v76
    v_fmac_f32 v132, v194, v78
    v_fmac_f32 v128, v187, v73
    v_fmac_f32 v130, v195, v75
    v_fmac_f32 v131, v195, v77
    v_fmac_f32 v132, v195, v79
    v_mfma_f32_32x32x8_bf16 v[64:79], v[244:245], v[244:245], 0
    v_smfmac_f32_32x32x32_bf16 v[64:79], v[236:239], v[32:39], v255
    buffer_load_dword v32, v220, s[12:15], 0 offen offset:0
    buffer_load_dword v33, v221, s[12:15], 0 offen offset:0
    buffer_load_dword v34, v222, s[12:15], 0 offen offset:0
    buffer_load_dword v35, v223, s[12:15], 0 offen offset:0
    buffer_load_dword v36, v224, s[12:15], 0 offen offset:0
    buffer_load_dword v37, v225, s[12:15], 0 offen offset:0
    buffer_load_dword v38, v226, s[12:15], 0 offen offset:0
    buffer_load_dword v39, v227, s[12:15], 0 offen offset:0
    v_mul_f32 v133, v196, v80
    v_mul_f32 v129, v188, v82
    v_mul_f32 v138, -v200, v84
    v_mul_f32 v137, v200, v86
    v_fmac_f32 v133, v197, v81
    v_fmac_f32 v129, v189, v83
    v_fma_f32 v138, -v201, v85, v138
    v_fmac_f32 v137, v201, v87
    v_fmac_f32 v133, v198, v88
    v_fmac_f32 v129, v190, v90
    v_fma_f32 v138, -v202, v92, v138
    v_fmac_f32 v137, v202, v94
    v_fmac_f32 v133, v199, v89
    v_fmac_f32 v129, v191, v91
    v_fma_f32 v138, -v203, v93, v138
    v_fmac_f32 v137, v203, v95
    v_mfma_f32_32x32x8_bf16 v[80:95], v[244:245], v[244:245], 0
    v_smfmac_f32_32x32x32_bf16 v[80:95], v[236:239], v[40:47], v255
    buffer_load_dword v40, v220, s[12:15], 0 offen offset:128
    buffer_load_dword v41, v221, s[12:15], 0 offen offset:128
    buffer_load_dword v42, v222, s[12:15], 0 offen offset:128
    buffer_load_dword v43, v223, s[12:15], 0 offen offset:128
    buffer_load_dword v44, v224, s[12:15], 0 offen offset:128
    buffer_load_dword v45, v225, s[12:15], 0 offen offset:128
    buffer_load_dword v46, v226, s[12:15], 0 offen offset:128
    buffer_load_dword v47, v227, s[12:15], 0 offen offset:128
    v_mul_f32 v134, v196, v96
    v_fmac_f32 v138, v200, v98
    v_fmac_f32 v129, v188, v100
    v_mul_f32 v136, -v200, v102
    v_fmac_f32 v134, v197, v97
    v_fmac_f32 v138, v201, v99
    v_fmac_f32 v129, v189, v101
    v_fma_f32 v136, -v201, v103, v136
    v_fmac_f32 v134, v198, v104
    v_fmac_f32 v138, v202, v106
    v_fmac_f32 v129, v190, v108
    v_fma_f32 v136, -v202, v110, v136
    v_fmac_f32 v134, v199, v105
    v_fmac_f32 v138, v203, v107
    v_fmac_f32 v129, v191, v109
    v_fma_f32 v136, -v203, v111, v136
    v_mfma_f32_32x32x8_bf16 v[96:111], v[244:245], v[244:245], 0
    v_smfmac_f32_32x32x32_bf16 v[96:111], v[236:239], v[48:55], v255
    buffer_load_dword v48, v220, s[12:15], 0 offen offset:256
    buffer_load_dword v49, v221, s[12:15], 0 offen offset:256
    buffer_load_dword v50, v222, s[12:15], 0 offen offset:256
    buffer_load_dword v51, v223, s[12:15], 0 offen offset:256
    buffer_load_dword v52, v224, s[12:15], 0 offen offset:256
    buffer_load_dword v53, v225, s[12:15], 0 offen offset:256
    buffer_load_dword v54, v226, s[12:15], 0 offen offset:256
    buffer_load_dword v55, v227, s[12:15], 0 offen offset:256
    v_mul_f32 v135, v196, v112
    v_fma_f32 v137, -v200, v114, v137
    v_fmac_f32 v136, v200, v116
    v_fmac_f32 v129, v188, v118
    v_fmac_f32 v135, v197, v113
    v_fma_f32 v137, -v201, v115, v137
    v_fmac_f32 v136, v201, v117
    v_fmac_f32 v129, v189, v119
    v_fmac_f32 v135, v198, v120
    v_fma_f32 v137, -v202, v122, v137
    v_fmac_f32 v136, v202, v124
    v_fmac_f32 v129, v190, v126
    v_fmac_f32 v135, v199, v121
    v_fma_f32 v137, -v203, v123, v137
    v_fmac_f32 v136, v203, v125
    v_fmac_f32 v129, v191, v127
    v_mfma_f32_32x32x8_bf16 v[112:127], v[244:245], v[244:245], 0
    v_smfmac_f32_32x32x32_bf16 v[112:127], v[236:239], v[56:63], v255
    buffer_load_dword v56, v220, s[12:15], 0 offen offset:384
    buffer_load_dword v57, v221, s[12:15], 0 offen offset:384
    buffer_load_dword v58, v222, s[12:15], 0 offen offset:384
    buffer_load_dword v59, v223, s[12:15], 0 offen offset:384
    buffer_load_dword v60, v224, s[12:15], 0 offen offset:384
    buffer_load_dword v61, v225, s[12:15], 0 offen offset:384
    buffer_load_dword v62, v226, s[12:15], 0 offen offset:384
    buffer_load_dword v63, v227, s[12:15], 0 offen offset:384
    v_cvt_pk_bf16_f32 v232, v128, v129
    v_cvt_pk_bf16_f32 v233, v130, v133
    v_cvt_pk_bf16_f32 v234, v131, v134
    v_cvt_pk_bf16_f32 v235, v132, v135
    v_cvt_pk_bf16_f32 v236, v136, v137
    v_cvt_pk_bf16_f32 v237, v138, v138
    ds_write2st64_b32 v139, v232, v233 offset0:0 offset1:1
    ds_write2st64_b32 v139, v234, v235 offset0:2 offset1:3
    ds_write_b16 v140, v236
    ds_write_b16_d16_hi v140, v236 offset:128
    ds_write_b16 v140, v237 offset:256
    v_add_u32 v139, 11520, v139
    v_add_u32 v140, 11520, v140
    s_and_b32 s47, s37, 15
    s_cmp_lg_u32 s47, 4
    s_cbranch_scc1 K2_PR5
    v_mov_b32 v238, 78856
    v_mov_b32 v239, 1
    s_mov_b64 exec, 1
    ds_add_u32 v238, v239
    s_mov_b64 exec, -1
K2_PR5:
    s_and_b32 s47, s37, 15
    s_cmp_lg_u32 s47, 2
    s_cbranch_scc1 K2_PR6
    s_setprio 2
K2_PR6:
    s_cmp_lg_u32 s47, 3
    s_cbranch_scc1 K2_PR7
    s_setprio 1
K2_PR7:
    s_cmp_lg_u32 s47, 4
    s_cbranch_scc1 K2_PR8
    s_setprio 0
K2_PR8:
    s_branch K2_NEXT1
K2_GEN1:
    s_cmp_ge_u32 s43, 2
    s_cbranch_scc1 K2_GW1
    s_waitcnt vmcnt(0)
K2_GW1:
    s_cmp_eq_u32 s35, 0
    s_cselect_b32 s39, s39, 0
K2_GL1:
    s_sub_u32 s41, s54, s49
    s_min_u32 s40, s41, 16
    s_lshl_b32 s47, s40, 5
    v_add_u32 v232, s47, v252
    ds_read_b128 v[228:231], v232
    s_lshl_b32 s47, s39, 5
    v_add_u32 v233, s47, v252
    ds_read_b128 v[236:239], v233
    s_waitcnt vmcnt(31) lgkmcnt(0)
    v_bitop3_b32 v232, v208, v228, v236 bitop3:0x40
    v_bitop3_b32 v233, v209, v229, v237 bitop3:0x40
    v_bitop3_b32 v234, v210, v230, v238 bitop3:0x40
    v_bitop3_b32 v235, v211, v231, v239 bitop3:0x40
    s_nop 1
    v_smfmac_f32_32x32x32_bf16 v[64:79], v[232:235], v[32:39], v255
    v_smfmac_f32_32x32x32_bf16 v[80:95], v[232:235], v[40:47], v255
    v_smfmac_f32_32x32x32_bf16 v[96:111], v[232:235], v[48:55], v255
    v_smfmac_f32_32x32x32_bf16 v[112:127], v[232:235], v[56:63], v255
    s_cmp_gt_u32 s41, 16
    s_cbranch_scc1 K2_GD1
    s_mov_b32 s42, 1
    s_branch K2_EPI
K2_GD1:
    s_cmp_le_u32 s43, 2
    s_cbranch_scc1 K2_NL1
    buffer_load_dword v32, v220, s[12:15], 0 offen offset:0
    buffer_load_dword v33, v221, s[12:15], 0 offen offset:0
    buffer_load_dword v34, v222, s[12:15], 0 offen offset:0
    buffer_load_dword v35, v223, s[12:15], 0 offen offset:0
    buffer_load_dword v36, v224, s[12:15], 0 offen offset:0
    buffer_load_dword v37, v225, s[12:15], 0 offen offset:0
    buffer_load_dword v38, v226, s[12:15], 0 offen offset:0
    buffer_load_dword v39, v227, s[12:15], 0 offen offset:0
    buffer_load_dword v40, v220, s[12:15], 0 offen offset:128
    buffer_load_dword v41, v221, s[12:15], 0 offen offset:128
    buffer_load_dword v42, v222, s[12:15], 0 offen offset:128
    buffer_load_dword v43, v223, s[12:15], 0 offen offset:128
    buffer_load_dword v44, v224, s[12:15], 0 offen offset:128
    buffer_load_dword v45, v225, s[12:15], 0 offen offset:128
    buffer_load_dword v46, v226, s[12:15], 0 offen offset:128
    buffer_load_dword v47, v227, s[12:15], 0 offen offset:128
    buffer_load_dword v48, v220, s[12:15], 0 offen offset:256
    buffer_load_dword v49, v221, s[12:15], 0 offen offset:256
    buffer_load_dword v50, v222, s[12:15], 0 offen offset:256
    buffer_load_dword v51, v223, s[12:15], 0 offen offset:256
    buffer_load_dword v52, v224, s[12:15], 0 offen offset:256
    buffer_load_dword v53, v225, s[12:15], 0 offen offset:256
    buffer_load_dword v54, v226, s[12:15], 0 offen offset:256
    buffer_load_dword v55, v227, s[12:15], 0 offen offset:256
    buffer_load_dword v56, v220, s[12:15], 0 offen offset:384
    buffer_load_dword v57, v221, s[12:15], 0 offen offset:384
    buffer_load_dword v58, v222, s[12:15], 0 offen offset:384
    buffer_load_dword v59, v223, s[12:15], 0 offen offset:384
    buffer_load_dword v60, v224, s[12:15], 0 offen offset:384
    buffer_load_dword v61, v225, s[12:15], 0 offen offset:384
    buffer_load_dword v62, v226, s[12:15], 0 offen offset:384
    buffer_load_dword v63, v227, s[12:15], 0 offen offset:384
K2_NL1:
    s_cmp_eq_u32 s43, 1
    s_cbranch_scc1 K2_STREAM_DONE
    s_sub_u32 s47, s54, 1
    s_and_b32 s40, s47, 15
    s_add_u32 s40, s40, 1
    s_lshr_b32 s47, s47, 4
    s_sub_i32 s48, s34, 2
    s_add_u32 s49, s35, 1
    s_max_i32 s48, s48, s49
    s_min_u32 s35, s47, s48
    s_sub_u32 s36, s35, s49
    s_lshl_b32 s47, s40, 5
    v_add_u32 v232, s47, v252
    ds_read_b128 v[228:231], v232
    s_branch K2_NEXT1
K2_EPI:
    s_add_u32 s37, s37, 1
    s_mov_b32 s39, s40
    v_readlane_b32 s54, v253, s37
    s_nop 7
    v_mul_f32 v128, v184, v64
    v_mul_f32 v130, v192, v66
    v_mul_f32 v131, v192, v68
    v_mul_f32 v132, v192, v70
    v_fmac_f32 v128, v185, v65
    v_fmac_f32 v130, v193, v67
    v_fmac_f32 v131, v193, v69
    v_fmac_f32 v132, v193, v71
    v_fmac_f32 v128, v186, v72
    v_fmac_f32 v130, v194, v74
    v_fmac_f32 v131, v194, v76
    v_fmac_f32 v132, v194, v78
    v_fmac_f32 v128, v187, v73
    v_fmac_f32 v130, v195, v75
    v_fmac_f32 v131, v195, v77
    v_fmac_f32 v132, v195, v79
    v_mfma_f32_32x32x8_bf16 v[64:79], v[244:245], v[244:245], 0
    v_mul_f32 v133, v196, v80
    v_mul_f32 v129, v188, v82
    v_mul_f32 v138, -v200, v84
    v_mul_f32 v137, v200, v86
    v_fmac_f32 v133, v197, v81
    v_fmac_f32 v129, v189, v83
    v_fma_f32 v138, -v201, v85, v138
    v_fmac_f32 v137, v201, v87
    v_fmac_f32 v133, v198, v88
    v_fmac_f32 v129, v190, v90
    v_fma_f32 v138, -v202, v92, v138
    v_fmac_f32 v137, v202, v94
    v_fmac_f32 v133, v199, v89
    v_fmac_f32 v129, v191, v91
    v_fma_f32 v138, -v203, v93, v138
    v_fmac_f32 v137, v203, v95
    v_mfma_f32_32x32x8_bf16 v[80:95], v[244:245], v[244:245], 0
    v_mul_f32 v134, v196, v96
    v_fmac_f32 v138, v200, v98
    v_fmac_f32 v129, v188, v100
    v_mul_f32 v136, -v200, v102
    v_fmac_f32 v134, v197, v97
    v_fmac_f32 v138, v201, v99
    v_fmac_f32 v129, v189, v101
    v_fma_f32 v136, -v201, v103, v136
    v_fmac_f32 v134, v198, v104
    v_fmac_f32 v138, v202, v106
    v_fmac_f32 v129, v190, v108
    v_fma_f32 v136, -v202, v110, v136
    v_fmac_f32 v134, v199, v105
    v_fmac_f32 v138, v203, v107
    v_fmac_f32 v129, v191, v109
    v_fma_f32 v136, -v203, v111, v136
    v_mfma_f32_32x32x8_bf16 v[96:111], v[244:245], v[244:245], 0
    v_mul_f32 v135, v196, v112
    v_fma_f32 v137, -v200, v114, v137
    v_fmac_f32 v136, v200, v116
    v_fmac_f32 v129, v188, v118
    v_fmac_f32 v135, v197, v113
    v_fma_f32 v137, -v201, v115, v137
    v_fmac_f32 v136, v201, v117
    v_fmac_f32 v129, v189, v119
    v_fmac_f32 v135, v198, v120
    v_fma_f32 v137, -v202, v122, v137
    v_fmac_f32 v136, v202, v124
    v_fmac_f32 v129, v190, v126
    v_fmac_f32 v135, v199, v121
    v_fma_f32 v137, -v203, v123, v137
    v_fmac_f32 v136, v203, v125
    v_fmac_f32 v129, v191, v127
    v_mfma_f32_32x32x8_bf16 v[112:127], v[244:245], v[244:245], 0
    s_cmp_lg_u32 s31, 0
    s_cbranch_scc1 K2_EPS
    v_cvt_pk_bf16_f32 v232, v128, v129
    v_cvt_pk_bf16_f32 v233, v130, v133
    v_cvt_pk_bf16_f32 v234, v131, v134
    v_cvt_pk_bf16_f32 v235, v132, v135
    v_cvt_pk_bf16_f32 v236, v136, v137
    v_cvt_pk_bf16_f32 v237, v138, v138
    ds_write2st64_b32 v139, v232, v233 offset0:0 offset1:1
    ds_write2st64_b32 v139, v234, v235 offset0:2 offset1:3
    ds_write_b16 v140, v236
    ds_write_b16_d16_hi v140, v236 offset:128
    ds_write_b16 v140, v237 offset:256
    v_add_u32 v139, 11520, v139
    v_add_u32 v140, 11520, v140
    s_and_b32 s47, s37, 15
    s_cmp_lg_u32 s47, 4
    s_cbranch_scc1 K2_PR9
    v_mov_b32 v238, 78856
    v_mov_b32 v239, 1
    s_mov_b64 exec, 1
    ds_add_u32 v238, v239
    s_mov_b64 exec, -1
K2_PR9:
    s_and_b32 s47, s37, 15
    s_cmp_lg_u32 s47, 2
    s_cbranch_scc1 K2_PR10
    s_setprio 2
K2_PR10:
    s_cmp_lg_u32 s47, 3
    s_cbranch_scc1 K2_PR11
    s_setprio 1
K2_PR11:
    s_cmp_lg_u32 s47, 4
    s_cbranch_scc1 K2_PR12
    s_setprio 0
K2_PR12:
K2_EPR:
    s_cmp_eq_u32 s54, 0x7fffffff
    s_cbranch_scc1 K2_STREAM_DONE
    s_cmp_eq_u32 s42, 0
    s_cbranch_scc1 K2_GL0
    s_branch K2_GL1
K2_EPS:
    s_waitcnt vmcnt(31)
    buffer_atomic_add_f32 v128, v141, s[16:19], 0 offen offset:0
    buffer_atomic_add_f32 v129, v141, s[16:19], 0 offen offset:256
    buffer_atomic_add_f32 v130, v141, s[16:19], 0 offen offset:512
    buffer_atomic_add_f32 v131, v141, s[16:19], 0 offen offset:768
    buffer_atomic_add_f32 v132, v141, s[16:19], 0 offen offset:1024
    buffer_atomic_add_f32 v133, v141, s[16:19], 0 offen offset:1280
    buffer_atomic_add_f32 v134, v141, s[16:19], 0 offen offset:1536
    buffer_atomic_add_f32 v135, v141, s[16:19], 0 offen offset:1792
    buffer_atomic_add_f32 v136, v141, s[16:19], 0 offen offset:2048
    buffer_atomic_add_f32 v137, v141, s[16:19], 0 offen offset:2304
    buffer_atomic_add_f32 v138, v141, s[16:19], 0 offen offset:2560
    v_add_u32 v141, 22528, v141
    s_waitcnt vmcnt(0)
    s_branch K2_EPR
K2_IZ0:
    v_mov_b32 v0, 0
    v_mov_b32 v8, 0
    v_mov_b32 v16, 0
    v_mov_b32 v24, 0
    s_branch K2_IN0
K2_IZ1:
    v_mov_b32 v1, 0
    v_mov_b32 v9, 0
    v_mov_b32 v17, 0
    v_mov_b32 v25, 0
    s_branch K2_IN1
K2_IZ2:
    v_mov_b32 v2, 0
    v_mov_b32 v10, 0
    v_mov_b32 v18, 0
    v_mov_b32 v26, 0
    s_branch K2_IN2
K2_IZ3:
    v_mov_b32 v3, 0
    v_mov_b32 v11, 0
    v_mov_b32 v19, 0
    v_mov_b32 v27, 0
    s_branch K2_IN3
K2_IZ4:
    v_mov_b32 v4, 0
    v_mov_b32 v12, 0
    v_mov_b32 v20, 0
    v_mov_b32 v28, 0
    s_branch K2_IN4
K2_IZ5:
    v_mov_b32 v5, 0
    v_mov_b32 v13, 0
    v_mov_b32 v21, 0
    v_mov_b32 v29, 0
    s_branch K2_IN5
K2_IZ6:
    v_mov_b32 v6, 0
    v_mov_b32 v14, 0
    v_mov_b32 v22, 0
    v_mov_b32 v30, 0
    s_branch K2_IN6
K2_EMPTY:
    s_cmp_lg_u32 s31, 0
    s_cbranch_scc1 K2_STREAM_DONE
    v_mov_b32 v128, 0
    v_mov_b32 v129, 0
    v_mov_b32 v130, 0
    v_mov_b32 v131, 0
    v_mov_b32 v132, 0
    v_mov_b32 v133, 0
    v_mov_b32 v134, 0
    v_mov_b32 v135, 0
    v_mov_b32 v136, 0
    v_mov_b32 v137, 0
    v_mov_b32 v138, 0
    s_mov_b32 s48, 5
K2_EMPTYL:
    v_cvt_pk_bf16_f32 v232, v128, v129
    v_cvt_pk_bf16_f32 v233, v130, v133
    v_cvt_pk_bf16_f32 v234, v131, v134
    v_cvt_pk_bf16_f32 v235, v132, v135
    v_cvt_pk_bf16_f32 v236, v136, v137
    v_cvt_pk_bf16_f32 v237, v138, v138
    ds_write2st64_b32 v139, v232, v233 offset0:0 offset1:1
    ds_write2st64_b32 v139, v234, v235 offset0:2 offset1:3
    ds_write_b16 v140, v236
    ds_write_b16_d16_hi v140, v236 offset:128
    ds_write_b16 v140, v237 offset:256
    v_add_u32 v139, 11520, v139
    v_add_u32 v140, 11520, v140
    s_sub_u32 s48, s48, 1
    s_cmp_lg_u32 s48, 0
    s_cbranch_scc1 K2_EMPTYL
    v_mov_b32 v238, 78856
    v_mov_b32 v239, 1
    s_mov_b64 exec, 1
    ds_add_u32 v238, v239
    s_mov_b64 exec, -1
    s_branch K2_POSTG
K2_GOSLOW:
    s_mov_b32 s31, 1
    s_mov_b32 s38, -1
    s_waitcnt vmcnt(0)
    ds_write_b128 v188, v[184:187]
    s_mul_i32 s47, s30, 1440
    s_add_u32 s47, s47, 78912
    v_lshl_add_u32 v139, v125, 2, s47
    s_add_u32 s47, s47, 1024
    v_lshl_add_u32 v140, v125, 1, s47
    s_mul_i32 s47, s28, 40
    s_add_u32 s47, s47, s30
    s_mul_i32 s47, s47, 2816
    s_add_u32 s47, s47, 13285376
    v_lshl_add_u32 v141, v125, 2, s47
    v_mov_b32 v128, 0
    buffer_store_dword v128, v141, s[16:19], 0 offen offset:0 sc1
    buffer_store_dword v128, v141, s[16:19], 0 offen offset:256 sc1
    buffer_store_dword v128, v141, s[16:19], 0 offen offset:512 sc1
    buffer_store_dword v128, v141, s[16:19], 0 offen offset:768 sc1
    buffer_store_dword v128, v141, s[16:19], 0 offen offset:1024 sc1
    buffer_store_dword v128, v141, s[16:19], 0 offen offset:1280 sc1
    buffer_store_dword v128, v141, s[16:19], 0 offen offset:1536 sc1
    buffer_store_dword v128, v141, s[16:19], 0 offen offset:1792 sc1
    buffer_store_dword v128, v141, s[16:19], 0 offen offset:2048 sc1
    buffer_store_dword v128, v141, s[16:19], 0 offen offset:2304 sc1
    buffer_store_dword v128, v141, s[16:19], 0 offen offset:2560 sc1
    v_add_u32 v141, 22528, v141
    s_waitcnt vmcnt(0)
    buffer_store_dword v128, v141, s[16:19], 0 offen offset:0 sc1
    buffer_store_dword v128, v141, s[16:19], 0 offen offset:256 sc1
    buffer_store_dword v128, v141, s[16:19], 0 offen offset:512 sc1
    buffer_store_dword v128, v141, s[16:19], 0 offen offset:768 sc1
    buffer_store_dword v128, v141, s[16:19], 0 offen offset:1024 sc1
    buffer_store_dword v128, v141, s[16:19], 0 offen offset:1280 sc1
    buffer_store_dword v128, v141, s[16:19], 0 offen offset:1536 sc1
    buffer_store_dword v128, v141, s[16:19], 0 offen offset:1792 sc1
    buffer_store_dword v128, v141, s[16:19], 0 offen offset:2048 sc1
    buffer_store_dword v128, v141, s[16:19], 0 offen offset:2304 sc1
    buffer_store_dword v128, v141, s[16:19], 0 offen offset:2560 sc1
    v_add_u32 v141, 22528, v141
    s_waitcnt vmcnt(0)
    buffer_store_dword v128, v141, s[16:19], 0 offen offset:0 sc1
    buffer_store_dword v128, v141, s[16:19], 0 offen offset:256 sc1
    buffer_store_dword v128, v141, s[16:19], 0 offen offset:512 sc1
    buffer_store_dword v128, v141, s[16:19], 0 offen offset:768 sc1
    buffer_store_dword v128, v141, s[16:19], 0 offen offset:1024 sc1
    buffer_store_dword v128, v141, s[16:19], 0 offen offset:1280 sc1
    buffer_store_dword v128, v141, s[16:19], 0 offen offset:1536 sc1
    buffer_store_dword v128, v141, s[16:19], 0 offen offset:1792 sc1
    buffer_store_dword v128, v141, s[16:19], 0 offen offset:2048 sc1
    buffer_store_dword v128, v141, s[16:19], 0 offen offset:2304 sc1
    buffer_store_dword v128, v141, s[16:19], 0 offen offset:2560 sc1
    v_add_u32 v141, 22528, v141
    s_waitcnt vmcnt(0)
    buffer_store_dword v128, v141, s[16:19], 0 offen offset:0 sc1
    buffer_store_dword v128, v141, s[16:19], 0 offen offset:256 sc1
    buffer_store_dword v128, v141, s[16:19], 0 offen offset:512 sc1
    buffer_store_dword v128, v141, s[16:19], 0 offen offset:768 sc1
    buffer_store_dword v128, v141, s[16:19], 0 offen offset:1024 sc1
    buffer_store_dword v128, v141, s[16:19], 0 offen offset:1280 sc1
    buffer_store_dword v128, v141, s[16:19], 0 offen offset:1536 sc1
    buffer_store_dword v128, v141, s[16:19], 0 offen offset:1792 sc1
    buffer_store_dword v128, v141, s[16:19], 0 offen offset:2048 sc1
    buffer_store_dword v128, v141, s[16:19], 0 offen offset:2304 sc1
    buffer_store_dword v128, v141, s[16:19], 0 offen offset:2560 sc1
    v_add_u32 v141, 22528, v141
    s_waitcnt vmcnt(0)
    buffer_store_dword v128, v141, s[16:19], 0 offen offset:0 sc1
    buffer_store_dword v128, v141, s[16:19], 0 offen offset:256 sc1
    buffer_store_dword v128, v141, s[16:19], 0 offen offset:512 sc1
    buffer_store_dword v128, v141, s[16:19], 0 offen offset:768 sc1
    buffer_store_dword v128, v141, s[16:19], 0 offen offset:1024 sc1
    buffer_store_dword v128, v141, s[16:19], 0 offen offset:1280 sc1
    buffer_store_dword v128, v141, s[16:19], 0 offen offset:1536 sc1
    buffer_store_dword v128, v141, s[16:19], 0 offen offset:1792 sc1
    buffer_store_dword v128, v141, s[16:19], 0 offen offset:2048 sc1
    buffer_store_dword v128, v141, s[16:19], 0 offen offset:2304 sc1
    buffer_store_dword v128, v141, s[16:19], 0 offen offset:2560 sc1
    v_add_u32 v141, 22528, v141
    s_waitcnt vmcnt(0)
    s_waitcnt vmcnt(0)
K2_SLOW_ROUND:
    s_waitcnt lgkmcnt(0)
    s_barrier
    s_nop 7
    v_mbcnt_lo_u32_b32 v125, -1, 0
    v_mbcnt_hi_u32_b32 v125, -1, v125
    v_lshlrev_b32 v2, 2, v125
    v_add_u32 v2, 77824, v2
    v_mov_b32 v3, 0
    ds_write2st64_b32 v2, v3, v3 offset0:0 offset1:1
    v_lshrrev_b32 v126, 4, v125
    s_lshl_b32 s47, s30, 5
    v_add_u32 v126, s47, v126
    v_and_b32 v127, 15, v125
    v_lshlrev_b32 v120, 10, v126
    s_lshl_b32 s47, s28, 2
    s_add_u32 s47, s47, 10880000
    buffer_load_dword v64, v120, s[16:19], s47 offen
    s_add_u32 s47, s47, 4096
    buffer_load_dword v65, v120, s[16:19], s47 offen
    s_add_u32 s47, s47, 4096
    buffer_load_dword v66, v120, s[16:19], s47 offen
    s_add_u32 s47, s47, 4096
    buffer_load_dword v67, v120, s[16:19], s47 offen
    s_add_u32 s47, s47, 4096
    buffer_load_dword v68, v120, s[16:19], s47 offen
    s_add_u32 s47, s47, 4096
    buffer_load_dword v69, v120, s[16:19], s47 offen
    s_add_u32 s47, s47, 4096
    buffer_load_dword v70, v120, s[16:19], s47 offen
    s_add_u32 s47, s47, 4096
    buffer_load_dword v71, v120, s[16:19], s47 offen
    v_add_u32 v121, s32, v127
    s_movk_i32 s47, 2500
    v_mad_u32_u24 v122, v126, s47, v121
    v_cmp_gt_u32 s[50:51], 8, v127
    s_mov_b64 s[52:53], 0
    v_mov_b32 v123, 0
    v_lshlrev_b32 v72, 1, v121
    v_subrev_u32 v73, 29, v72
    v_min_u32 v72, v72, v73
    v_lshl_add_u32 v72, v126, 13, v72
    s_lshl_b32 s47, s28, 5
    s_add_u32 s47, s47, 11142144
    v_add_u32 v72, s47, v72
    s_waitcnt vmcnt(0)
    v_lshrrev_b32 v120, 16, v64
    v_and_b32 v104, 0xffff, v64
    v_cmp_lt_u32 vcc, v121, v120
    v_add_u32 v104, v104, v122
    v_lshlrev_b32 v112, 4, v104
    v_max_u32 v123, v123, v120
    v_mov_b32 v96, 0
    s_and_b64 s[56:57], vcc, s[50:51]
    s_mov_b64 exec, s[56:57]
    s_cbranch_execz K2_SR0
    s_mov_b32 s47, 0
    buffer_load_dwordx4 v[0:3], v112, s[16:19], s47 offen
    v_cmp_lt_u32 vcc, 30, v120
    v_add_u32 v104, 10240000, v104
    v_add_u32 v120, 0, v72
    v_cndmask_b32 v104, v120, v104, vcc
    buffer_load_ubyte v96, v104, s[16:19], 0 offen
K2_SR0:
    s_mov_b64 exec, -1
    v_lshrrev_b32 v120, 16, v65
    v_and_b32 v105, 0xffff, v65
    v_cmp_lt_u32 vcc, v121, v120
    v_add_u32 v105, v105, v122
    v_lshlrev_b32 v113, 4, v105
    v_max_u32 v123, v123, v120
    v_mov_b32 v97, 0
    s_and_b64 s[58:59], vcc, s[50:51]
    s_mov_b64 exec, s[58:59]
    s_cbranch_execz K2_SR1
    s_mov_b32 s47, 160000
    buffer_load_dwordx4 v[4:7], v113, s[16:19], s47 offen
    v_cmp_lt_u32 vcc, 30, v120
    v_add_u32 v105, 10250000, v105
    v_add_u32 v120, 32768, v72
    v_cndmask_b32 v105, v120, v105, vcc
    buffer_load_ubyte v97, v105, s[16:19], 0 offen
K2_SR1:
    s_mov_b64 exec, -1
    v_lshrrev_b32 v120, 16, v66
    v_and_b32 v106, 0xffff, v66
    v_cmp_lt_u32 vcc, v121, v120
    v_add_u32 v106, v106, v122
    v_lshlrev_b32 v114, 4, v106
    v_max_u32 v123, v123, v120
    v_mov_b32 v98, 0
    s_and_b64 s[60:61], vcc, s[50:51]
    s_mov_b64 exec, s[60:61]
    s_cbranch_execz K2_SR2
    s_mov_b32 s47, 320000
    buffer_load_dwordx4 v[8:11], v114, s[16:19], s47 offen
    v_cmp_lt_u32 vcc, 30, v120
    v_add_u32 v106, 10260000, v106
    v_add_u32 v120, 65536, v72
    v_cndmask_b32 v106, v120, v106, vcc
    buffer_load_ubyte v98, v106, s[16:19], 0 offen
K2_SR2:
    s_mov_b64 exec, -1
    v_lshrrev_b32 v120, 16, v67
    v_and_b32 v107, 0xffff, v67
    v_cmp_lt_u32 vcc, v121, v120
    v_add_u32 v107, v107, v122
    v_lshlrev_b32 v115, 4, v107
    v_max_u32 v123, v123, v120
    v_mov_b32 v99, 0
    s_and_b64 s[62:63], vcc, s[50:51]
    s_mov_b64 exec, s[62:63]
    s_cbranch_execz K2_SR3
    s_mov_b32 s47, 480000
    buffer_load_dwordx4 v[12:15], v115, s[16:19], s47 offen
    v_cmp_lt_u32 vcc, 30, v120
    v_add_u32 v107, 10270000, v107
    v_add_u32 v120, 98304, v72
    v_cndmask_b32 v107, v120, v107, vcc
    buffer_load_ubyte v99, v107, s[16:19], 0 offen
K2_SR3:
    s_mov_b64 exec, -1
    v_lshrrev_b32 v120, 16, v68
    v_and_b32 v108, 0xffff, v68
    v_cmp_lt_u32 vcc, v121, v120
    v_add_u32 v108, v108, v122
    v_lshlrev_b32 v116, 4, v108
    v_max_u32 v123, v123, v120
    v_mov_b32 v100, 0
    s_and_b64 s[64:65], vcc, s[50:51]
    s_mov_b64 exec, s[64:65]
    s_cbranch_execz K2_SR4
    s_mov_b32 s47, 640000
    buffer_load_dwordx4 v[16:19], v116, s[16:19], s47 offen
    v_cmp_lt_u32 vcc, 30, v120
    v_add_u32 v108, 10280000, v108
    v_add_u32 v120, 131072, v72
    v_cndmask_b32 v108, v120, v108, vcc
    buffer_load_ubyte v100, v108, s[16:19], 0 offen
K2_SR4:
    s_mov_b64 exec, -1
    v_lshrrev_b32 v120, 16, v69
    v_and_b32 v109, 0xffff, v69
    v_cmp_lt_u32 vcc, v121, v120
    v_add_u32 v109, v109, v122
    v_lshlrev_b32 v117, 4, v109
    v_max_u32 v123, v123, v120
    v_mov_b32 v101, 0
    s_and_b64 s[66:67], vcc, s[50:51]
    s_mov_b64 exec, s[66:67]
    s_cbranch_execz K2_SR5
    s_mov_b32 s47, 800000
    buffer_load_dwordx4 v[20:23], v117, s[16:19], s47 offen
    v_cmp_lt_u32 vcc, 30, v120
    v_add_u32 v109, 10290000, v109
    v_add_u32 v120, 163840, v72
    v_cndmask_b32 v109, v120, v109, vcc
    buffer_load_ubyte v101, v109, s[16:19], 0 offen
K2_SR5:
    s_mov_b64 exec, -1
    v_lshrrev_b32 v120, 16, v70
    v_and_b32 v110, 0xffff, v70
    v_cmp_lt_u32 vcc, v121, v120
    v_add_u32 v110, v110, v122
    v_lshlrev_b32 v118, 4, v110
    v_max_u32 v123, v123, v120
    v_mov_b32 v102, 0
    s_and_b64 s[68:69], vcc, s[50:51]
    s_mov_b64 exec, s[68:69]
    s_cbranch_execz K2_SR6
    s_mov_b32 s47, 960000
    buffer_load_dwordx4 v[24:27], v118, s[16:19], s47 offen
    v_cmp_lt_u32 vcc, 30, v120
    v_add_u32 v110, 10300000, v110
    v_add_u32 v120, 196608, v72
    v_cndmask_b32 v110, v120, v110, vcc
    buffer_load_ubyte v102, v110, s[16:19], 0 offen
K2_SR6:
    s_mov_b64 exec, -1
    v_lshrrev_b32 v120, 16, v71
    v_and_b32 v111, 0xffff, v71
    v_cmp_lt_u32 vcc, v121, v120
    v_add_u32 v111, v111, v122
    v_lshlrev_b32 v119, 4, v111
    v_max_u32 v123, v123, v120
    v_mov_b32 v103, 0
    s_and_b64 s[70:71], vcc, s[50:51]
    s_mov_b64 exec, s[70:71]
    s_cbranch_execz K2_SR7
    s_mov_b32 s47, 1120000
    buffer_load_dwordx4 v[28:31], v119, s[16:19], s47 offen
    v_cmp_lt_u32 vcc, 30, v120
    v_add_u32 v111, 10310000, v111
    v_add_u32 v120, 229376, v72
    v_cndmask_b32 v111, v120, v111, vcc
    buffer_load_ubyte v103, v111, s[16:19], 0 offen
K2_SR7:
    s_mov_b64 exec, -1
    v_mov_b32 v120, 78852
    ds_max_u32 v120, v123
    v_mov_b32 v124, 77824
    s_waitcnt vmcnt(0) lgkmcnt(0)
    s_barrier
    ds_read_b32 v120, v120
    s_waitcnt lgkmcnt(0)
    v_readfirstlane_b32 s33, v120
    v_mov_b32 v120, 1
    v_lshl_add_u32 v96, v96, 2, v124
    v_lshl_add_u32 v97, v97, 2, v124
    v_lshl_add_u32 v98, v98, 2, v124
    v_lshl_add_u32 v99, v99, 2, v124
    v_lshl_add_u32 v100, v100, 2, v124
    v_lshl_add_u32 v101, v101, 2, v124
    v_lshl_add_u32 v102, v102, 2, v124
    v_lshl_add_u32 v103, v103, 2, v124
    s_mov_b64 exec, s[56:57]
    ds_add_rtn_u32 v80, v96, v120
    s_mov_b64 exec, s[58:59]
    ds_add_rtn_u32 v81, v97, v120
    s_mov_b64 exec, s[60:61]
    ds_add_rtn_u32 v82, v98, v120
    s_mov_b64 exec, s[62:63]
    ds_add_rtn_u32 v83, v99, v120
    s_mov_b64 exec, s[64:65]
    ds_add_rtn_u32 v84, v100, v120
    s_mov_b64 exec, s[66:67]
    ds_add_rtn_u32 v85, v101, v120
    s_mov_b64 exec, s[68:69]
    ds_add_rtn_u32 v86, v102, v120
    s_mov_b64 exec, s[70:71]
    ds_add_rtn_u32 v87, v103, v120
    s_mov_b64 exec, -1
    s_branch K2_RANKD
K2_STREAM_DONE:
    s_cmp_eq_u32 s31, 0
    s_cbranch_scc1 K2_POSTG
    s_add_u32 s32, s32, 8
    s_cmp_lt_u32 s32, s33
    s_cbranch_scc1 K2_SLOW_ROUND
    s_nop 7
    v_mbcnt_lo_u32_b32 v125, -1, 0
    v_mbcnt_hi_u32_b32 v125, -1, v125
    s_mul_i32 s47, s30, 1440
    s_add_u32 s47, s47, 78912
    v_lshl_add_u32 v139, v125, 2, s47
    s_add_u32 s47, s47, 1024
    v_lshl_add_u32 v140, v125, 1, s47
    s_mul_i32 s47, s28, 40
    s_add_u32 s47, s47, s30
    s_mul_i32 s47, s47, 2816
    s_add_u32 s47, s47, 13285376
    v_lshl_add_u32 v141, v125, 2, s47
    s_mov_b32 s48, 5
K2_SLOWL:
    buffer_load_dword v128, v141, s[16:19], 0 offen offset:0 sc1
    buffer_load_dword v129, v141, s[16:19], 0 offen offset:256 sc1
    buffer_load_dword v130, v141, s[16:19], 0 offen offset:512 sc1
    buffer_load_dword v131, v141, s[16:19], 0 offen offset:768 sc1
    buffer_load_dword v132, v141, s[16:19], 0 offen offset:1024 sc1
    buffer_load_dword v133, v141, s[16:19], 0 offen offset:1280 sc1
    buffer_load_dword v134, v141, s[16:19], 0 offen offset:1536 sc1
    buffer_load_dword v135, v141, s[16:19], 0 offen offset:1792 sc1
    buffer_load_dword v136, v141, s[16:19], 0 offen offset:2048 sc1
    buffer_load_dword v137, v141, s[16:19], 0 offen offset:2304 sc1
    buffer_load_dword v138, v141, s[16:19], 0 offen offset:2560 sc1
    v_add_u32 v141, 22528, v141
    s_waitcnt vmcnt(0)
    v_cvt_pk_bf16_f32 v232, v128, v129
    v_cvt_pk_bf16_f32 v233, v130, v133
    v_cvt_pk_bf16_f32 v234, v131, v134
    v_cvt_pk_bf16_f32 v235, v132, v135
    v_cvt_pk_bf16_f32 v236, v136, v137
    v_cvt_pk_bf16_f32 v237, v138, v138
    ds_write2st64_b32 v139, v232, v233 offset0:0 offset1:1
    ds_write2st64_b32 v139, v234, v235 offset0:2 offset1:3
    ds_write_b16 v140, v236
    ds_write_b16_d16_hi v140, v236 offset:128
    ds_write_b16 v140, v237 offset:256
    v_add_u32 v139, 11520, v139
    v_add_u32 v140, 11520, v140
    s_sub_u32 s48, s48, 1
    s_cmp_lg_u32 s48, 0
    s_cbranch_scc1 K2_SLOWL
    v_mov_b32 v238, 78856
    v_mov_b32 v239, 1
    s_mov_b64 exec, 1
    ds_add_u32 v238, v239
    s_mov_b64 exec, -1
K2_POSTG:
    s_cmp_lg_u32 s88, 0
    s_cbranch_scc1 K2_NOWF
    v_mbcnt_lo_u32_b32 v226, -1, 0
    v_mbcnt_hi_u32_b32 v226, -1, v226
    s_mul_i32 s47, s30, 10240
    v_lshlrev_b32 v226, 4, v226
    s_add_u32 s47, s47, 13239296
    buffer_load_dwordx4 v[144:147], v226, s[16:19], s47 offen offset:0
    buffer_load_dwordx4 v[148:151], v226, s[16:19], s47 offen offset:1024
    buffer_load_dwordx4 v[152:155], v226, s[16:19], s47 offen offset:2048
    buffer_load_dwordx4 v[156:159], v226, s[16:19], s47 offen offset:3072
    s_add_u32 s47, s47, 4096
    buffer_load_dwordx4 v[160:163], v226, s[16:19], s47 offen offset:0
    buffer_load_dwordx4 v[164:167], v226, s[16:19], s47 offen offset:1024
    buffer_load_dwordx4 v[168:171], v226, s[16:19], s47 offen offset:2048
    buffer_load_dwordx4 v[172:175], v226, s[16:19], s47 offen offset:3072
    s_add_u32 s47, s47, 4096
    buffer_load_dwordx4 v[176:179], v226, s[16:19], s47 offen offset:0
    buffer_load_dwordx4 v[180:183], v226, s[16:19], s47 offen offset:1024
    s_mov_b32 s88, 1
K2_NOWF:
    v_mbcnt_lo_u32_b32 v246, -1, 0
    v_mbcnt_hi_u32_b32 v246, -1, v246
    s_cmp_ge_u32 s30, 4
    s_cbranch_scc1 K2_GADDR
    v_and_b32 v226, 15, v246
    v_lshrrev_b32 v227, 4, v246
    v_mul_u32_u24 v220, 1440, v226
    v_lshl_add_u32 v220, v227, 4, v220
    v_add_u32 v220, 78912, v220
    s_lshl_b32 s49, s30, 5
    s_add_u32 s47, s49, 141632
    v_mul_u32_u24 v221, 528, v226
    v_lshl_add_u32 v221, v227, 3, v221
    v_add_u32 v221, s47, v221
    v_and_b32 v0, 7, v226
    v_lshrrev_b32 v1, 3, v226
    v_mul_u32_u24 v224, 1440, v0
    v_lshl_add_u32 v224, v227, 4, v224
    v_add_u32 v224, 124992, v224
    v_lshl_add_u32 v222, v1, 8, v224
    v_lshl_add_u32 v223, v1, 7, v224
    v_cmp_eq_u32 s[50:51], 1, v1
    v_mul_u32_u24 v225, 528, v0
    v_lshl_add_u32 v225, v227, 3, v225
    s_add_u32 s47, s49, 158528
    v_add_u32 v225, s47, v225
    v_lshl_add_u32 v226, v1, 7, v225
    v_mul_u32_u24 v1, 384, v1
    v_sub_u32 v227, v225, v1
    v_mov_b32 v196, 0xbfb8aa3b
    s_setprio 0
    v_mov_b32 v2, 78856
    s_mov_b32 s48, 0
K2_SPIN:
    ds_read_b32 v3, v2
    s_add_u32 s48, s48, 1
    s_waitcnt lgkmcnt(0)
    v_readfirstlane_b32 s47, v3
    s_nop 3
    s_cmp_ge_u32 s47, 8
    s_cbranch_scc1 K2_SPIND
    s_cmp_gt_u32 s48, 0x400000
    s_cbranch_scc1 K2_SPIND
    s_sleep 1
    s_branch K2_SPIN
K2_SPIND:
    ds_read_b128 v[64:67], v220 offset:0
    ds_read_b128 v[68:71], v220 offset:64
    ds_read_b128 v[72:75], v220 offset:128
    ds_read_b128 v[76:79], v220 offset:192
    ds_read_b128 v[80:83], v220 offset:23040
    ds_read_b128 v[84:87], v220 offset:23104
    ds_read_b128 v[88:91], v220 offset:23168
    ds_read_b128 v[92:95], v220 offset:23232
    ds_read_b128 v[96:99], v220 offset:256
    ds_read_b128 v[100:103], v220 offset:320
    ds_read_b128 v[104:107], v220 offset:384
    ds_read_b128 v[108:111], v220 offset:448
    s_waitcnt vmcnt(0)
    s_waitcnt lgkmcnt(10)
    v_mfma_f32_16x16x32_bf16 v[0:3], v[144:147], v[64:67], 0
    ds_read_b128 v[112:115], v220 offset:1024
    v_mfma_f32_16x16x32_bf16 v[0:3], v[148:151], v[68:71], v[0:3]
    ds_read_b128 v[116:119], v220 offset:1088
    s_waitcnt lgkmcnt(10)
    v_mfma_f32_16x16x32_bf16 v[0:3], v[152:155], v[72:75], v[0:3]
    ds_read_b128 v[120:123], v220 offset:512
    v_mfma_f32_16x16x32_bf16 v[0:3], v[156:159], v[76:79], v[0:3]
    ds_read_b128 v[124:127], v220 offset:576
    s_waitcnt lgkmcnt(10)
    v_mfma_f32_16x16x32_bf16 v[4:7], v[144:147], v[80:83], 0
    ds_read_b128 v[64:67], v220 offset:640
    v_mfma_f32_16x16x32_bf16 v[4:7], v[148:151], v[84:87], v[4:7]
    ds_read_b128 v[68:71], v220 offset:704
    s_waitcnt lgkmcnt(10)
    v_mfma_f32_16x16x32_bf16 v[4:7], v[152:155], v[88:91], v[4:7]
    ds_read_b128 v[72:75], v220 offset:1152
    v_mfma_f32_16x16x32_bf16 v[4:7], v[156:159], v[92:95], v[4:7]
    ds_read_b128 v[76:79], v220 offset:1216
    s_waitcnt lgkmcnt(10)
    v_mfma_f32_16x16x32_bf16 v[12:15], v[160:163], v[96:99], 0
    ds_read_b128 v[80:83], v220 offset:768
    v_mfma_f32_16x16x32_bf16 v[12:15], v[164:167], v[100:103], v[12:15]
    ds_read_b128 v[84:87], v220 offset:832
    s_waitcnt lgkmcnt(10)
    v_mfma_f32_16x16x32_bf16 v[12:15], v[168:171], v[104:107], v[12:15]
    ds_read_b128 v[88:91], v220 offset:896
    v_mfma_f32_16x16x32_bf16 v[12:15], v[172:175], v[108:111], v[12:15]
    ds_read_b128 v[92:95], v220 offset:960
    s_waitcnt lgkmcnt(10)
    v_mfma_f32_16x16x32_bf16 v[12:15], v[176:179], v[112:115], v[12:15]
    ds_read_b128 v[96:99], v220 offset:1280
    v_mul_f32 v184, v196, v0
    v_mul_f32 v185, v196, v1
    v_mfma_f32_16x16x32_bf16 v[12:15], v[180:183], v[116:119], v[12:15]
    ds_read_b128 v[100:103], v220 offset:1344
    v_mul_f32 v186, v196, v2
    v_mul_f32 v187, v196, v3
    s_waitcnt lgkmcnt(10)
    v_mfma_f32_16x16x32_bf16 v[16:19], v[160:163], v[120:123], 0
    ds_read_b128 v[104:107], v220 offset:23296
    v_mul_f32 v188, v196, v4
    v_mul_f32 v189, v196, v5
    v_mfma_f32_16x16x32_bf16 v[16:19], v[164:167], v[124:127], v[16:19]
    ds_read_b128 v[108:111], v220 offset:23360
    v_mul_f32 v190, v196, v6
    v_mul_f32 v191, v196, v7
    s_waitcnt lgkmcnt(10)
    v_mfma_f32_16x16x32_bf16 v[16:19], v[168:171], v[64:67], v[16:19]
    ds_read_b128 v[112:115], v220 offset:23424
    v_exp_f32 v184, v184
    v_exp_f32 v185, v185
    v_mfma_f32_16x16x32_bf16 v[16:19], v[172:175], v[68:71], v[16:19]
    ds_read_b128 v[116:119], v220 offset:23488
    v_exp_f32 v186, v186
    v_exp_f32 v187, v187
    s_waitcnt lgkmcnt(10)
    v_mfma_f32_16x16x32_bf16 v[16:19], v[176:179], v[72:75], v[16:19]
    ds_read_b128 v[120:123], v220 offset:24064
    v_exp_f32 v188, v188
    v_exp_f32 v189, v189
    v_mfma_f32_16x16x32_bf16 v[16:19], v[180:183], v[76:79], v[16:19]
    ds_read_b128 v[124:127], v220 offset:24128
    v_exp_f32 v190, v190
    v_exp_f32 v191, v191
    s_waitcnt lgkmcnt(10)
    v_mfma_f32_16x16x32_bf16 v[20:23], v[160:163], v[80:83], 0
    ds_read_b128 v[64:67], v220 offset:23552
    v_add_f32 v184, 1.0, v184
    v_add_f32 v185, 1.0, v185
    v_mfma_f32_16x16x32_bf16 v[20:23], v[164:167], v[84:87], v[20:23]
    ds_read_b128 v[68:71], v220 offset:23616
    v_add_f32 v186, 1.0, v186
    v_add_f32 v187, 1.0, v187
    s_waitcnt lgkmcnt(10)
    v_mfma_f32_16x16x32_bf16 v[20:23], v[168:171], v[88:91], v[20:23]
    ds_read_b128 v[72:75], v220 offset:23680
    v_add_f32 v188, 1.0, v188
    v_add_f32 v189, 1.0, v189
    v_mfma_f32_16x16x32_bf16 v[20:23], v[172:175], v[92:95], v[20:23]
    ds_read_b128 v[76:79], v220 offset:23744
    v_add_f32 v190, 1.0, v190
    v_add_f32 v191, 1.0, v191
    s_waitcnt lgkmcnt(10)
    v_mfma_f32_16x16x32_bf16 v[20:23], v[176:179], v[96:99], v[20:23]
    ds_read_b128 v[80:83], v220 offset:24192
    v_rcp_f32 v184, v184
    v_rcp_f32 v185, v185
    v_mfma_f32_16x16x32_bf16 v[20:23], v[180:183], v[100:103], v[20:23]
    ds_read_b128 v[84:87], v220 offset:24256
    v_rcp_f32 v186, v186
    v_rcp_f32 v187, v187
    s_waitcnt lgkmcnt(10)
    v_mfma_f32_16x16x32_bf16 v[24:27], v[160:163], v[104:107], 0
    ds_read_b128 v[88:91], v220 offset:23808
    v_rcp_f32 v188, v188
    v_rcp_f32 v189, v189
    v_mfma_f32_16x16x32_bf16 v[24:27], v[164:167], v[108:111], v[24:27]
    ds_read_b128 v[92:95], v220 offset:23872
    v_rcp_f32 v190, v190
    v_rcp_f32 v191, v191
    s_waitcnt lgkmcnt(10)
    v_mfma_f32_16x16x32_bf16 v[24:27], v[168:171], v[112:115], v[24:27]
    ds_read_b128 v[96:99], v220 offset:23936
    v_cvt_pk_bf16_f32 v198, v0, v1
    v_cvt_pk_bf16_f32 v199, v2, v3
    v_mfma_f32_16x16x32_bf16 v[24:27], v[172:175], v[116:119], v[24:27]
    ds_read_b128 v[100:103], v220 offset:24000
    v_cvt_pk_bf16_f32 v200, v4, v5
    v_cvt_pk_bf16_f32 v201, v6, v7
    s_waitcnt lgkmcnt(10)
    v_mfma_f32_16x16x32_bf16 v[24:27], v[176:179], v[120:123], v[24:27]
    ds_read_b128 v[104:107], v220 offset:24320
    v_mul_f32 v12, v12, v184
    v_mul_f32 v13, v13, v185
    v_mfma_f32_16x16x32_bf16 v[24:27], v[180:183], v[124:127], v[24:27]
    ds_read_b128 v[108:111], v220 offset:24384
    v_mul_f32 v14, v14, v186
    v_mul_f32 v15, v15, v187
    s_waitcnt lgkmcnt(10)
    v_mfma_f32_16x16x32_bf16 v[28:31], v[160:163], v[64:67], 0
    v_cvt_pk_bf16_f32 v204, v12, v13
    v_cvt_pk_bf16_f32 v205, v14, v15
    v_mul_f32 v16, v16, v184
    v_mfma_f32_16x16x32_bf16 v[28:31], v[164:167], v[68:71], v[28:31]
    v_mul_f32 v17, v17, v185
    v_mul_f32 v18, v18, v186
    v_mul_f32 v19, v19, v187
    s_waitcnt lgkmcnt(8)
    v_mfma_f32_16x16x32_bf16 v[28:31], v[168:171], v[72:75], v[28:31]
    v_cvt_pk_bf16_f32 v206, v16, v17
    v_cvt_pk_bf16_f32 v207, v18, v19
    v_mul_f32 v20, v20, v184
    v_mfma_f32_16x16x32_bf16 v[28:31], v[172:175], v[76:79], v[28:31]
    v_mul_f32 v21, v21, v185
    v_mul_f32 v22, v22, v186
    v_mul_f32 v23, v23, v187
    s_waitcnt lgkmcnt(6)
    v_mfma_f32_16x16x32_bf16 v[28:31], v[176:179], v[80:83], v[28:31]
    v_cvt_pk_bf16_f32 v208, v20, v21
    v_cvt_pk_bf16_f32 v209, v22, v23
    v_mul_f32 v24, v24, v188
    v_mfma_f32_16x16x32_bf16 v[28:31], v[180:183], v[84:87], v[28:31]
    v_mul_f32 v25, v25, v189
    v_mul_f32 v26, v26, v190
    v_mul_f32 v27, v27, v191
    s_waitcnt lgkmcnt(4)
    v_mfma_f32_16x16x32_bf16 v[32:35], v[160:163], v[88:91], 0
    v_cvt_pk_bf16_f32 v210, v24, v25
    v_cvt_pk_bf16_f32 v211, v26, v27
    v_mfma_f32_16x16x32_bf16 v[32:35], v[164:167], v[92:95], v[32:35]
    s_waitcnt lgkmcnt(2)
    v_mfma_f32_16x16x32_bf16 v[32:35], v[168:171], v[96:99], v[32:35]
    v_mfma_f32_16x16x32_bf16 v[32:35], v[172:175], v[100:103], v[32:35]
    s_waitcnt lgkmcnt(0)
    v_mfma_f32_16x16x32_bf16 v[32:35], v[176:179], v[104:107], v[32:35]
    v_mul_f32 v28, v28, v188
    v_mul_f32 v29, v29, v189
    v_mul_f32 v30, v30, v190
    v_mfma_f32_16x16x32_bf16 v[32:35], v[180:183], v[108:111], v[32:35]
    v_mul_f32 v31, v31, v191
    v_cvt_pk_bf16_f32 v212, v28, v29
    v_cvt_pk_bf16_f32 v213, v30, v31
    ds_write_b64 v221, v[198:199] offset:0
    ds_write_b64 v221, v[204:205] offset:128
    ds_write_b64 v221, v[206:207] offset:256
    ds_write_b64 v221, v[208:209] offset:384
    ds_write_b64 v221, v[200:201] offset:8448
    ds_write_b64 v221, v[210:211] offset:8576
    ds_write_b64 v221, v[212:213] offset:8704
    s_nop 1
    v_mul_f32 v32, v32, v188
    v_mul_f32 v33, v33, v189
    v_mul_f32 v34, v34, v190
    v_mul_f32 v35, v35, v191
    v_cvt_pk_bf16_f32 v214, v32, v33
    v_cvt_pk_bf16_f32 v215, v34, v35
    ds_write_b64 v221, v[214:215] offset:8832
K2_GADDR:
    s_and_b32 s47, s30, 3
    s_lshl_b32 s47, s47, 6
    v_add_u32 v229, s47, v246
    v_lshrrev_b32 v228, 5, v229
    v_and_b32 v230, 31, v229
    v_mul_u32_u24 v228, 528, v228
    v_lshl_add_u32 v228, v230, 4, v228
    v_add_u32 v228, 141632, v228
    v_lshlrev_b32 v229, 4, v229
    s_waitcnt lgkmcnt(0)
    s_barrier
    s_cmp_lt_u32 s30, 4
    s_cbranch_scc1 K2_GEMM2
    ds_read_b128 v[4:7], v228 offset:0
    ds_read_b128 v[8:11], v228 offset:4224
    ds_read_b128 v[12:15], v228 offset:8448
    ds_read_b128 v[16:19], v228 offset:12672
    v_add_u32 v231, 4096, v229
    v_add_u32 v232, 8192, v229
    v_add_u32 v233, 12288, v229
    s_waitcnt lgkmcnt(3)
    buffer_store_dwordx4 v[4:7], v229, s[20:23], 0 offen sc1
    s_waitcnt lgkmcnt(2)
    buffer_store_dwordx4 v[8:11], v231, s[20:23], 0 offen sc1
    s_waitcnt lgkmcnt(1)
    buffer_store_dwordx4 v[12:15], v232, s[20:23], 0 offen sc1
    s_waitcnt lgkmcnt(0)
    buffer_store_dwordx4 v[16:19], v233, s[20:23], 0 offen sc1
    s_barrier
    s_branch K2_FIN
K2_GEMM2:
    ds_read_b128 v[64:67], v224 offset:0
    ds_read_b128 v[68:71], v224 offset:64
    ds_read_b128 v[72:75], v224 offset:128
    ds_read_b128 v[76:79], v224 offset:192
    ds_read_b128 v[80:83], v222 offset:256
    ds_read_b128 v[84:87], v222 offset:320
    ds_read_b128 v[88:91], v222 offset:384
    ds_read_b128 v[92:95], v222 offset:448
    ds_read_b128 v[96:99], v223 offset:1024
    ds_read_b128 v[100:103], v223 offset:1088
    ds_read_b128 v[104:107], v224 offset:768
    ds_read_b128 v[108:111], v224 offset:832
    s_waitcnt vmcnt(0)
    s_waitcnt lgkmcnt(10)
    v_mfma_f32_16x16x32_bf16 v[8:11], v[144:147], v[64:67], 0
    ds_read_b128 v[112:115], v224 offset:896
    v_mfma_f32_16x16x32_bf16 v[8:11], v[148:151], v[68:71], v[8:11]
    ds_read_b128 v[116:119], v224 offset:960
    s_waitcnt lgkmcnt(10)
    v_mfma_f32_16x16x32_bf16 v[8:11], v[152:155], v[72:75], v[8:11]
    ds_read_b128 v[120:123], v224 offset:1280
    v_mfma_f32_16x16x32_bf16 v[8:11], v[156:159], v[76:79], v[8:11]
    ds_read_b128 v[124:127], v224 offset:1344
    s_waitcnt lgkmcnt(10)
    v_mfma_f32_16x16x32_bf16 v[36:39], v[160:163], v[80:83], 0
    v_mfma_f32_16x16x32_bf16 v[36:39], v[164:167], v[84:87], v[36:39]
    s_waitcnt lgkmcnt(8)
    v_mfma_f32_16x16x32_bf16 v[36:39], v[168:171], v[88:91], v[36:39]
    v_mfma_f32_16x16x32_bf16 v[36:39], v[172:175], v[92:95], v[36:39]
    s_waitcnt lgkmcnt(6)
    v_mfma_f32_16x16x32_bf16 v[36:39], v[176:179], v[96:99], v[36:39]
    v_mfma_f32_16x16x32_bf16 v[36:39], v[180:183], v[100:103], v[36:39]
    v_mul_f32 v192, v196, v8
    v_mul_f32 v193, v196, v9
    v_mul_f32 v194, v196, v10
    s_waitcnt lgkmcnt(4)
    v_mfma_f32_16x16x32_bf16 v[40:43], v[160:163], v[104:107], 0
    v_mul_f32 v195, v196, v11
    v_exp_f32 v192, v192
    v_exp_f32 v193, v193
    v_mfma_f32_16x16x32_bf16 v[40:43], v[164:167], v[108:111], v[40:43]
    v_exp_f32 v194, v194
    v_exp_f32 v195, v195
    v_add_f32 v192, 1.0, v192
    s_waitcnt lgkmcnt(2)
    v_mfma_f32_16x16x32_bf16 v[40:43], v[168:171], v[112:115], v[40:43]
    v_add_f32 v193, 1.0, v193
    v_add_f32 v194, 1.0, v194
    v_add_f32 v195, 1.0, v195
    v_mfma_f32_16x16x32_bf16 v[40:43], v[172:175], v[116:119], v[40:43]
    v_rcp_f32 v192, v192
    v_rcp_f32 v193, v193
    v_rcp_f32 v194, v194
    s_waitcnt lgkmcnt(0)
    v_mfma_f32_16x16x32_bf16 v[40:43], v[176:179], v[120:123], v[40:43]
    v_rcp_f32 v195, v195
    v_cvt_pk_bf16_f32 v202, v8, v9
    v_cvt_pk_bf16_f32 v203, v10, v11
    v_mfma_f32_16x16x32_bf16 v[40:43], v[180:183], v[124:127], v[40:43]
    v_mul_f32 v36, v36, v192
    v_mul_f32 v37, v37, v193
    v_mul_f32 v38, v38, v194
    v_mul_f32 v39, v39, v195
    v_cvt_pk_bf16_f32 v216, v36, v37
    v_cvt_pk_bf16_f32 v217, v38, v39
    ds_write_b64 v226, v[216:217] offset:128
    s_nop 4
    v_mul_f32 v40, v40, v192
    v_mul_f32 v41, v41, v193
    v_mul_f32 v42, v42, v194
    v_mul_f32 v43, v43, v195
    v_cvt_pk_bf16_f32 v218, v40, v41
    v_cvt_pk_bf16_f32 v219, v42, v43
    v_cndmask_b32 v218, v218, v202, s[50:51]
    v_cndmask_b32 v219, v219, v203, s[50:51]
    ds_write_b64 v227, v[218:219] offset:384
    v_add_u32 v229, 16384, v229
    s_waitcnt lgkmcnt(0)
    s_barrier
    ds_read_b128 v[4:7], v228 offset:16896
    s_waitcnt lgkmcnt(0)
    buffer_store_dwordx4 v[4:7], v229, s[20:23], 0 offen sc1
K2_FIN:
K2_END:
    s_endpgm
CODE_END:
.section .rodata,"a"
.p2align 6
.amdhsa_kernel tp_part_kernel
  .amdhsa_next_free_vgpr 80
  .amdhsa_next_free_sgpr 72
  .amdhsa_accum_offset 80
  .amdhsa_group_segment_fixed_size 0
  .amdhsa_kernarg_size 96
  .amdhsa_user_sgpr_count 2
  .amdhsa_user_sgpr_kernarg_segment_ptr 1
  .amdhsa_system_sgpr_workgroup_id_x 1
  .amdhsa_float_denorm_mode_32 3
.end_amdhsa_kernel
.p2align 6
.amdhsa_kernel tp_main_kernel
  .amdhsa_next_free_vgpr 256
  .amdhsa_next_free_sgpr 92
  .amdhsa_accum_offset 256
  .amdhsa_group_segment_fixed_size 0
  .amdhsa_kernarg_size 96
  .amdhsa_user_sgpr_count 2
  .amdhsa_user_sgpr_kernarg_segment_ptr 1
  .amdhsa_system_sgpr_workgroup_id_x 1
  .amdhsa_float_denorm_mode_32 3
.end_amdhsa_kernel
```
